```python
import torch

def _softmax(x, axis=-1):
    return torch.softmax(x, dim=axis)
def _gelu(x):
    return torch.nn.functional.gelu(x, approximate="tanh")
def _silu(x):
    return torch.nn.functional.silu(x)
def _sigmoid(x):
    return torch.sigmoid(x)
def _layernorm(x, axis=-1, eps=1e-5):
    m = x.mean(dim=axis, keepdim=True)
    v = x.var(dim=axis, keepdim=True, unbiased=False)
    return (x - m) / torch.sqrt(v + eps)
def _scatter_add(tgt, idx, src, axis=0):
    return tgt.clone().index_add_(axis, idx, src)
def _segment_sum(src, seg, n):
    out = torch.zeros((n,) + src.shape[1:], dtype=src.dtype)
    return out.index_add_(0, seg, src)
def _pad(x, pw):
    flat = tuple(v for pair in reversed(pw) for v in pair)
    return torch.nn.functional.pad(x, flat)

kernel_name = 'concat_heads__linear_kernel_hedgehog__spectral_fnet__prompt'

def setup_inputs():

    _w = (lambda a: (lambda t: t.to(torch.bfloat16) if t.is_floating_point() else t)(torch.as_tensor(a)))
    def _A_setup():
        B, S, D, H = 1, 2048, 576, 32
        Dh = D // H
        return {
            "x": _w((lambda *s: torch.randn(*s, dtype=torch.bfloat16) * 0.2)(B, S, D)),
            "wqkv": _w((lambda *s: torch.randn(*s, dtype=torch.bfloat16) * 1.6)(D, 3 * D)),
            "w_phi": _w((lambda *s: torch.randn(*s, dtype=torch.bfloat16) * 1.6)(H, Dh, Dh) * (Dh ** -0.5)),
            "wo": _w((lambda *s: torch.randn(*s, dtype=torch.bfloat16) * 0.8)(D, D)),
        }
    _A_in = _A_setup()

    def _B_setup():
        B, S, D = 1, 2048, 576
        ns = torch.arange(S)[:, None] * torch.arange(S)[None, :]
        nd = torch.arange(D)[:, None] * torch.arange(D)[None, :]
        Ws_re = torch.cos(-2.0 * torch.pi * ns / S).to(float)
        Ws_im = torch.sin(-2.0 * torch.pi * ns / S).to(float)
        Wd_re = torch.cos(-2.0 * torch.pi * nd / D).to(float)
        Wd_im = torch.sin(-2.0 * torch.pi * nd / D).to(float)
        return {
            "x": _w((lambda *s: torch.randn(*s, dtype=torch.bfloat16) * 0.05)(B, S, D)),
            "dft_seq_re": _w(Ws_re),
            "dft_seq_im": _w(Ws_im),
            "dft_hid_re": _w(Wd_re),
            "dft_hid_im": _w(Wd_im),
        }
    _B_in = _B_setup()

    return {
        "A_x": _A_in["x"],
        "A_wqkv": _A_in["wqkv"],
        "A_w_phi": _A_in["w_phi"],
        "A_wo": _A_in["wo"],
        "B_x": _B_in["x"],
        "B_dft_seq_re": _B_in["dft_seq_re"],
        "B_dft_seq_im": _B_in["dft_seq_im"],
        "B_dft_hid_re": _B_in["dft_hid_re"],
        "B_dft_hid_im": _B_in["dft_hid_im"],
    }

def reference(A_x, A_wqkv, A_w_phi, A_wo, B_x, B_dft_seq_re, B_dft_seq_im, B_dft_hid_re, B_dft_hid_im):
    def _A_ref(x, wqkv, w_phi, wo):
        B, S, D = x.shape
        H = 32; Dh = D // H
        qkv = (lambda x, *d: x.permute(*d))((x @ wqkv).reshape(B, S, 3, H, Dh), 2, 0, 3, 1, 4)
        q, k, v = qkv[0], qkv[1], qkv[2]
        pq = torch.einsum("bhsd,hdf->bhsf", q, w_phi)
        pk = torch.einsum("bhsd,hdf->bhsf", k, w_phi)
        phi_q = torch.concatenate([_softmax(pq, axis=-1), _softmax(-pq, axis=-1)], axis=-1)
        phi_k = torch.concatenate([_softmax(pk, axis=-1), _softmax(-pk, axis=-1)], axis=-1)
        kv = torch.einsum("bhsf,bhsd->bhfd", phi_k, v)
        z  = torch.einsum("bhsf->bhf", phi_k)
        num = torch.einsum("bhqf,bhfd->bhqd", phi_q, kv)
        den = torch.einsum("bhqf,bhf->bhq", phi_q, z)[..., None] + 1e-6
        o = num / den
        return (lambda x, *d: x.permute(*d))(o, 0, 2, 1, 3).reshape(B, S, D) @ wo

    def _B_ref(x, dft_seq_re, dft_seq_im, dft_hid_re, dft_hid_im):
        a = torch.einsum("bsd,ed->bse", x, dft_hid_re)
        b = torch.einsum("bsd,ed->bse", x, dft_hid_im)
        y = torch.einsum("ts,bse->bte", dft_seq_re, a) - torch.einsum("ts,bse->bte", dft_seq_im, b)
        return y

    a = _A_ref(A_x, A_wqkv, A_w_phi, A_wo)
    b = _B_ref(B_x, B_dft_seq_re, B_dft_seq_im, B_dft_hid_re, B_dft_hid_im)
    return torch.concatenate([a, b], axis=-1)
```

```asm
; @launch grid=(256,1,1) block=(512,1,1) lds=163840
.amdgcn_target "amdgcn-amd-amdhsa--gfx950"
.text
.globl concat_heads__linear_kernel_hedgehog__spectral_fnet__prompt_kernel
.p2align 8
.type concat_heads__linear_kernel_hedgehog__spectral_fnet__prompt_kernel,@function
concat_heads__linear_kernel_hedgehog__spectral_fnet__prompt_kernel:
  s_cmp_ge_u32 s2, 256
  s_cbranch_scc1 L_end
  s_load_dwordx8 s[4:11], s[0:1], 0
  s_load_dwordx2 s[14:15], s[0:1], 88
  s_load_dwordx2 s[12:13], s[0:1], 32
  s_load_dwordx4 s[16:19], s[0:1], 56
  s_load_dwordx4 s[20:23], s[0:1], 72
  v_lshrrev_b32 v2, 6, v0
  v_and_b32 v1, 63, v0
  v_readfirstlane_b32 s44, v2
  v_and_b32 v6, 255, v0
  s_and_b32 s45, s2, 7
  s_lshr_b32 s3, s2, 3
  s_and_b32 s62, s45, 3
  s_lshl_b32 s62, s62, 2
  s_and_b32 s48, s3, 3
  s_add_u32 s62, s62, s48
  s_lshr_b32 s51, s44, 2
  s_mov_b32 s71, 0
  s_and_b32 s44, s44, 3
  s_lshl_b32 s64, s44, 12
  s_lshr_b32 s48, s45, 2
  s_lshr_b32 s49, s3, 2
  s_lshl_b32 s50, s48, 2
  s_add_u32 s50, s50, s49
  s_lshl_b32 s48, s48, 1
  s_and_b32 s49, s49, 1
  s_add_u32 s48, s48, s49
  s_cmp_lt_u32 s3, 16
  s_cselect_b32 s63, s50, s48
  s_cmp_eq_u32 s51, 0
  s_cbranch_scc1 L_c
  s_mov_b32 s71, 1
  v_and_b32 v2, 7, v1
  v_lshrrev_b32 v3, 4, v1
  v_xor_b32 v2, v2, v3
  v_lshlrev_b32 v14, 4, v2
  v_lshrrev_b32 v5, 3, v1
  s_lshl_b32 s48, s45, 2
  s_lshr_b32 s59, 409232416, s48
  s_and_b32 s59, s59, 15
  s_cmp_ge_u32 s3, 24
  s_cbranch_scc1 L_bl
  v_mul_u32_u24 v2, 1152, v5
  v_add_u32 v7, v2, v14
  v_xor_b32 v8, 64, v7
  s_lshl_b32 s48, s62, 2
  s_add_u32 s48, s48, s44
  s_mul_i32 s56, s48, 36864
  s_mov_b32 s58, 221184
  s_lshl_b32 s65, s44, 10
  s_mul_i32 s51, s63, 144
  s_lshl_b32 s52, s51, 1
  s_add_u32 s51, s51, 1152
  s_cmp_lt_u32 s3, 16
  s_cselect_b32 s57, s51, s52
  s_cselect_b32 s55, 1008, 0
  v_add_u32 v2, 0, v6
  v_mul_u32_u24 v3, 1821, v2
  v_lshrrev_b32 v3, 15, v3
  v_mul_u32_u24 v4, 18, v3
  v_sub_u32 v2, v2, v4
  v_lshrrev_b32 v4, 1, v3
  v_xor_b32 v4, v4, v3
  v_and_b32 v4, 4, v4
  v_mul_u32_u24 v4, 3, v4
  v_xor_b32 v3, v3, v4
  v_mul_u32_u24 v3, 3456, v3
  v_cmp_gt_u32 vcc, 9, v2
  v_lshl_add_u32 v3, v2, 4, v3
  v_add_u32 v4, s55, v3
  v_cndmask_b32 v9, v4, v3, vcc
  v_add_u32 v2, 256, v6
  v_mul_u32_u24 v3, 1821, v2
  v_lshrrev_b32 v3, 15, v3
  v_mul_u32_u24 v4, 18, v3
  v_sub_u32 v2, v2, v4
  v_lshrrev_b32 v4, 1, v3
  v_xor_b32 v4, v4, v3
  v_and_b32 v4, 4, v4
  v_mul_u32_u24 v4, 3, v4
  v_xor_b32 v3, v3, v4
  v_mul_u32_u24 v3, 3456, v3
  v_cmp_gt_u32 vcc, 9, v2
  v_lshl_add_u32 v3, v2, 4, v3
  v_add_u32 v4, s55, v3
  v_cndmask_b32 v10, v4, v3, vcc
  s_waitcnt lgkmcnt(0)
  s_mov_b32 s24, s4
  s_and_b32 s25, s5, 0xffff
  s_mov_b32 s26, 2359296
  s_mov_b32 s27, 0x20000
  s_mov_b32 s28, s6
  s_and_b32 s29, s7, 0xffff
  s_mov_b32 s30, 1990656
  s_mov_b32 s31, 0x20000
  s_lshl_b32 s54, s3, 2
  s_add_u32 s54, s54, s44
  s_add_u32 s54, s54, 4294967264
  s_lshl_b32 s48, s44, 4
  s_add_u32 s48, s48, s3
  s_add_u32 s48, s48, 64
  s_cmp_lt_u32 s44, 0
  s_cselect_b32 s48, s48, 1000
  s_cmp_lt_u32 s3, 16
  s_cselect_b32 s54, s48, s54
  s_add_u32 s48, s54, 0
  s_mul_i32 s49, s48, 2850
  s_lshr_b32 s49, s49, 16
  s_mul_i32 s50, s49, 23
  s_sub_u32 s48, s48, s50
  s_cmp_ge_u32 s49, 9
  s_cbranch_scc1 L_hd_2
  s_add_u32 s49, s49, s59
  s_cmp_ge_u32 s49, 9
  s_cselect_b32 s50, 9, 0
  s_sub_u32 s49, s49, s50
  s_cmp_ge_u32 s48, 8
  s_cbranch_scc1 L_hw_1
  s_and_b32 s50, s45, 3
  s_lshl_b32 s50, s50, 3
  s_add_u32 s50, s50, s48
  s_mul_i32 s50, s50, 73728
  s_lshl_b32 s49, s49, 7
  s_add_u32 s50, s50, s49
  v_mul_u32_u24 v2, 1152, v1
  buffer_load_dword v253, v2, s[24:27], s50 offen
  s_branch L_hd_2
L_hw_1:
  s_sub_u32 s48, s48, 8
  s_mul_i32 s50, s48, 52
  s_lshr_b32 s50, s50, 8
  s_mul_i32 s51, s50, 5
  s_sub_u32 s48, s48, s51
  s_add_u32 s50, s50, 1
  s_cmp_eq_u32 s50, 3
  s_cselect_b32 s50, 0, s50
  s_mul_i32 s50, s50, 1152
  s_lshl_b32 s48, s48, 7
  s_add_u32 s50, s50, s48
  s_lshr_b32 s48, s45, 2
  s_lshl_b32 s48, s48, 9
  s_add_u32 s50, s50, s48
  s_mul_i32 s49, s49, 221184
  s_add_u32 s50, s50, s49
  v_mul_u32_u24 v2, 3456, v1
  buffer_load_dword v253, v2, s[28:31], s50 offen
L_hd_2:
L_al_go:
  s_lshl_b32 s60, s59, 7
  s_add_u32 s60, s60, s56
  s_mul_i32 s61, s59, s58
  s_add_u32 s61, s61, s57
  s_add_u32 s59, s59, 1
  s_cmp_eq_u32 s59, 9
  s_cselect_b32 s59, 0, s59
  s_add_u32 m0, s64, 110592
  s_nop 0
  buffer_load_dwordx4 v7, s[24:27], s60 offen lds
  s_add_u32 s60, s60, 9216
  s_add_u32 m0, s64, 111616
  s_nop 0
  buffer_load_dwordx4 v8, s[24:27], s60 offen lds
  s_add_u32 s60, s60, 9216
  s_add_u32 m0, s64, 112640
  s_nop 0
  buffer_load_dwordx4 v7, s[24:27], s60 offen lds
  s_add_u32 s60, s60, 9216
  s_add_u32 m0, s64, 113664
  s_nop 0
  buffer_load_dwordx4 v8, s[24:27], s60 offen lds
  s_add_u32 m0, s65, 126976
  s_nop 0
  buffer_load_dwordx4 v9, s[28:31], s61 offen lds
  s_add_u32 m0, s65, 131072
  s_nop 0
  buffer_load_dwordx4 v10, s[28:31], s61 offen lds
  v_add_u32 v2, 512, v6
  v_mul_u32_u24 v3, 1821, v2
  v_lshrrev_b32 v3, 15, v3
  v_mul_u32_u24 v4, 18, v3
  v_sub_u32 v2, v2, v4
  v_lshrrev_b32 v4, 1, v3
  v_xor_b32 v4, v4, v3
  v_and_b32 v4, 4, v4
  v_mul_u32_u24 v4, 3, v4
  v_xor_b32 v3, v3, v4
  v_mul_u32_u24 v3, 3456, v3
  v_cmp_gt_u32 vcc, 9, v2
  v_lshl_add_u32 v3, v2, 4, v3
  v_add_u32 v4, s55, v3
  v_cndmask_b32 v11, v4, v3, vcc
  s_add_u32 m0, s65, 135168
  s_nop 0
  buffer_load_dwordx4 v11, s[28:31], s61 offen lds
  v_add_u32 v2, 768, v6
  v_mul_u32_u24 v3, 1821, v2
  v_lshrrev_b32 v3, 15, v3
  v_mul_u32_u24 v4, 18, v3
  v_sub_u32 v2, v2, v4
  v_lshrrev_b32 v4, 1, v3
  v_xor_b32 v4, v4, v3
  v_and_b32 v4, 4, v4
  v_mul_u32_u24 v4, 3, v4
  v_xor_b32 v3, v3, v4
  v_mul_u32_u24 v3, 3456, v3
  v_cmp_gt_u32 vcc, 9, v2
  v_lshl_add_u32 v3, v2, 4, v3
  v_add_u32 v4, s55, v3
  v_cndmask_b32 v12, v4, v3, vcc
  s_add_u32 m0, s65, 139264
  s_nop 0
  buffer_load_dwordx4 v12, s[28:31], s61 offen lds
  v_add_u32 v2, 1024, v6
  v_mul_u32_u24 v3, 1821, v2
  v_lshrrev_b32 v3, 15, v3
  v_mul_u32_u24 v4, 18, v3
  v_sub_u32 v2, v2, v4
  v_lshrrev_b32 v4, 1, v3
  v_xor_b32 v4, v4, v3
  v_and_b32 v4, 4, v4
  v_mul_u32_u24 v4, 3, v4
  v_xor_b32 v3, v3, v4
  v_mul_u32_u24 v3, 3456, v3
  v_cmp_gt_u32 vcc, 9, v2
  v_lshl_add_u32 v3, v2, 4, v3
  v_add_u32 v4, s55, v3
  v_cndmask_b32 v13, v4, v3, vcc
  s_cmp_ge_u32 s44, 2
  s_cselect_b32 s48, 1073741824, 0
  v_add_u32 v13, s48, v13
  s_add_u32 m0, s65, 143360
  s_nop 0
  buffer_load_dwordx4 v13, s[28:31], s61 offen lds
  s_add_u32 s52, s14, 3383296
  s_addc_u32 s53, s15, 0
  s_load_dword s72, s[52:53], 0
  s_mov_b32 s32, s14
  s_and_b32 s33, s15, 0xffff
  s_mov_b32 s34, 9437184
  s_mov_b32 s35, 0x20000
  s_mov_b32 s36, s10
  s_and_b32 s37, s11, 0xffff
  s_mov_b32 s38, 663552
  s_mov_b32 s39, 0x20000
  s_mov_b32 s46, 1069066811
  s_mov_b32 s47, 1069066811
  s_lshl_b32 s66, s45, 1
  s_and_b32 s48, s3, 1
  s_add_u32 s66, s66, s48
  s_lshr_b32 s48, s3, 1
  s_and_b32 s49, s3, 0x1e
  s_sub_u32 s49, s49, 8
  s_add_u32 s49, s49, s71
  s_cmp_lt_u32 s3, 16
  s_cselect_b32 s67, s48, s49
  v_add_u32 v2, 0, v1
  v_mul_u32_u24 v3, 171, v2
  v_lshrrev_b32 v3, 11, v3
  v_mul_u32_u24 v4, 12, v3
  v_sub_u32 v2, v2, v4
  v_lshrrev_b32 v4, 2, v3
  v_and_b32 v4, 2, v4
  v_xor_b32 v2, v2, v4
  v_mul_u32_u24 v3, 1152, v3
  v_lshl_add_u32 v15, v2, 4, v3
  v_add_u32 v2, 64, v1
  v_mul_u32_u24 v3, 171, v2
  v_lshrrev_b32 v3, 11, v3
  v_mul_u32_u24 v4, 12, v3
  v_sub_u32 v2, v2, v4
  v_lshrrev_b32 v4, 2, v3
  v_and_b32 v4, 2, v4
  v_xor_b32 v2, v2, v4
  v_mul_u32_u24 v3, 1152, v3
  v_lshl_add_u32 v16, v2, 4, v3
  v_add_u32 v2, 128, v1
  v_mul_u32_u24 v3, 171, v2
  v_lshrrev_b32 v3, 11, v3
  v_mul_u32_u24 v4, 12, v3
  v_sub_u32 v2, v2, v4
  v_lshrrev_b32 v4, 2, v3
  v_and_b32 v4, 2, v4
  v_xor_b32 v2, v2, v4
  v_mul_u32_u24 v3, 1152, v3
  v_lshl_add_u32 v17, v2, 4, v3
  s_lshr_b32 s48, s3, 2
  s_mul_i32 s69, s48, 192
  s_mul_i32 s48, s44, 18432
  s_add_u32 s69, s69, s48
  s_mul_i32 s70, s44, 3072
  v_mov_b32 v20, -1
  v_mov_b32 v21, -1
  v_mov_b32 v22, -1
  v_mov_b32 v23, -1
  s_lshl_b32 s48, s63, 1
  s_lshr_b32 s49, s44, 1
  s_add_u32 s48, s48, s49
  s_lshl_b32 s48, s48, 4
  s_add_u32 s48, s48, s62
  s_lshl_b32 s48, s48, 1
  s_and_b32 s49, s44, 1
  s_add_u32 s48, s48, s49
  s_mul_i32 s51, s48, 1536
  s_add_u32 s51, s51, 0
  s_lshr_b32 s49, s3, 4
  s_sub_u32 s48, s67, s49
  s_lshl_b32 s48, s48, 2
  s_add_u32 s54, s48, s44
  s_lshl_b32 s48, s54, 5
  s_add_u32 s48, s48, s66
  s_lshl_b32 s101, s48, 7
  s_add_u32 s101, s101, 2883584
  s_lshl_b32 s73, s48, 10
  s_add_u32 s73, s73, 786432
  s_add_u32 s74, s73, 16384
  s_add_u32 s48, s73, 131072
  s_add_u32 s49, s73, 147456
  s_add_u32 s50, s51, 1024
  s_cmp_lt_u32 s3, 16
  s_cselect_b32 s75, s51, s48
  s_cselect_b32 s100, s50, s49
  s_cselect_b32 s48, 32, 64
  s_cselect_b32 s49, 16, 32
  v_mov_b32 v5, 1073741824
  v_lshlrev_b32 v18, 4, v1
  v_cmp_gt_u32 vcc, s48, v1
  s_nop 1
  v_cndmask_b32 v19, v5, v18, vcc
  v_and_b32 v2, 7, v1
  v_lshlrev_b32 v2, 4, v2
  v_bfe_u32 v3, v1, 3, 1
  v_lshl_add_u32 v2, v3, 11, v2
  v_bfe_u32 v3, v1, 4, 1
  v_lshl_add_u32 v2, v3, 14, v2
  v_cmp_gt_u32 vcc, s49, v1
  s_nop 1
  v_cndmask_b32 v24, v5, v2, vcc
  s_lshl_b32 s48, s54, 4
  s_add_u32 s48, s48, s66
  s_lshl_b32 s48, s48, 7
  s_add_u32 s48, s48, 3252224
  s_add_u32 s49, s48, 8192
  s_lshl_b32 s50, s63, 2
  s_add_u32 s50, s50, s44
  s_lshl_b32 s50, s50, 4
  s_add_u32 s50, s50, s62
  s_lshl_b32 s50, s50, 7
  s_add_u32 s50, s50, 3186688
  s_cmp_lt_u32 s3, 16
  s_cselect_b32 s49, s50, s49
  v_mov_b32 v25, s49
  v_mov_b32 v2, s48
  v_cmp_eq_u32 vcc, 0, v1
  s_nop 1
  v_cndmask_b32 v25, v25, v2, vcc
  v_and_b32 v52, 1, v1
  v_lshrrev_b32 v26, 5, v1
  v_cmp_eq_u32 vcc, v52, v26
  v_mul_u32_u24 v27, 1920, v52
  v_bfe_u32 v52, v1, 2, 2
  v_mad_u32_u24 v27, v52, 40, v27
  v_add_u32 v27, 148480, v27
  v_mov_b32 v52, 158720
  v_cndmask_b32 v27, v52, v27, vcc
  v_bfe_u32 v52, v1, 4, 1
  v_lshl_add_u32 v26, v52, 4, v27
  v_bfe_u32 v52, v1, 1, 1
  v_lshl_add_u32 v26, v52, 3, v26
  v_and_b32 v2, 31, v1
  s_lshl_b32 s48, s44, 5
  v_add_u32 v2, s48, v2
  v_mul_u32_u24 v2, 464, v2
  v_lshrrev_b32 v3, 5, v1
  v_mul_u32_u24 v3, 224, v3
  v_add_u32 v53, v2, v3
  v_add_u32 v53, 89088, v53
  s_add_u32 s48, s64, 73728
  v_lshl_add_u32 v54, v1, 4, s48
  v_mov_b32 v65, 0
  v_mov_b32 v66, 0
  v_mov_b32 v67, 0
  s_waitcnt lgkmcnt(0)
  s_add_u32 s72, s72, 1
  s_lshl_b32 s60, s59, 7
  s_add_u32 s60, s60, s56
  s_mul_i32 s61, s59, s58
  s_add_u32 s61, s61, s57
  s_add_u32 s59, s59, 1
  s_cmp_eq_u32 s59, 9
  s_cselect_b32 s59, 0, s59
  s_add_u32 m0, s64, 0
  s_nop 0
  buffer_load_dwordx4 v7, s[24:27], s60 offen lds
  s_add_u32 s60, s60, 9216
  s_add_u32 m0, s64, 1024
  s_nop 0
  buffer_load_dwordx4 v8, s[24:27], s60 offen lds
  s_add_u32 s60, s60, 9216
  s_add_u32 m0, s64, 2048
  s_nop 0
  buffer_load_dwordx4 v7, s[24:27], s60 offen lds
  s_add_u32 s60, s60, 9216
  s_add_u32 m0, s64, 3072
  s_nop 0
  buffer_load_dwordx4 v8, s[24:27], s60 offen lds
  s_add_u32 m0, s65, 16384
  s_nop 0
  buffer_load_dwordx4 v9, s[28:31], s61 offen lds
  s_waitcnt vmcnt(5)
  s_barrier
  s_add_u32 m0, s65, 20480
  s_nop 0
  buffer_load_dwordx4 v10, s[28:31], s61 offen lds
  s_add_u32 m0, s65, 24576
  s_nop 0
  buffer_load_dwordx4 v11, s[28:31], s61 offen lds
  s_add_u32 m0, s65, 28672
  s_nop 0
  buffer_load_dwordx4 v12, s[28:31], s61 offen lds
  s_add_u32 m0, s65, 32768
  s_nop 0
  buffer_load_dwordx4 v13, s[28:31], s61 offen lds
  s_lshl_b32 s60, s59, 7
  s_add_u32 s60, s60, s56
  s_mul_i32 s61, s59, s58
  s_add_u32 s61, s61, s57
  s_add_u32 s59, s59, 1
  s_cmp_eq_u32 s59, 9
  s_cselect_b32 s59, 0, s59
  s_add_u32 m0, s64, 36864
  s_nop 0
  buffer_load_dwordx4 v7, s[24:27], s60 offen lds
  s_add_u32 s60, s60, 9216
  s_add_u32 m0, s64, 37888
  s_nop 0
  buffer_load_dwordx4 v8, s[24:27], s60 offen lds
  s_add_u32 s60, s60, 9216
  s_add_u32 m0, s64, 38912
  s_nop 0
  buffer_load_dwordx4 v7, s[24:27], s60 offen lds
  s_add_u32 s60, s60, 9216
  s_add_u32 m0, s64, 39936
  s_nop 0
  buffer_load_dwordx4 v8, s[24:27], s60 offen lds
  s_add_u32 m0, s65, 53248
  s_nop 0
  buffer_load_dwordx4 v9, s[28:31], s61 offen lds
  s_waitcnt vmcnt(5)
  s_barrier
  s_add_u32 m0, s65, 57344
  s_nop 0
  buffer_load_dwordx4 v10, s[28:31], s61 offen lds
  s_add_u32 m0, s65, 61440
  s_nop 0
  buffer_load_dwordx4 v11, s[28:31], s61 offen lds
  s_add_u32 m0, s65, 65536
  s_nop 0
  buffer_load_dwordx4 v12, s[28:31], s61 offen lds
  s_add_u32 m0, s65, 69632
  s_nop 0
  buffer_load_dwordx4 v13, s[28:31], s61 offen lds
  s_lshl_b32 s60, s59, 7
  s_add_u32 s60, s60, s56
  s_mul_i32 s61, s59, s58
  s_add_u32 s61, s61, s57
  s_add_u32 s59, s59, 1
  s_cmp_eq_u32 s59, 9
  s_cselect_b32 s59, 0, s59
  s_add_u32 m0, s64, 73728
  s_nop 0
  buffer_load_dwordx4 v7, s[24:27], s60 offen lds
  s_add_u32 s60, s60, 9216
  s_add_u32 m0, s64, 74752
  s_nop 0
  buffer_load_dwordx4 v8, s[24:27], s60 offen lds
  s_add_u32 s60, s60, 9216
  s_add_u32 m0, s64, 75776
  s_nop 0
  buffer_load_dwordx4 v7, s[24:27], s60 offen lds
  s_add_u32 s60, s60, 9216
  s_add_u32 m0, s64, 76800
  s_nop 0
  buffer_load_dwordx4 v8, s[24:27], s60 offen lds
  s_add_u32 m0, s65, 90112
  s_nop 0
  buffer_load_dwordx4 v9, s[28:31], s61 offen lds
  s_waitcnt vmcnt(5)
  s_barrier
  s_add_u32 m0, s65, 94208
  s_nop 0
  buffer_load_dwordx4 v10, s[28:31], s61 offen lds
  s_add_u32 m0, s65, 98304
  s_nop 0
  buffer_load_dwordx4 v11, s[28:31], s61 offen lds
  s_add_u32 m0, s65, 102400
  s_nop 0
  buffer_load_dwordx4 v12, s[28:31], s61 offen lds
  s_add_u32 m0, s65, 106496
  s_nop 0
  buffer_load_dwordx4 v13, s[28:31], s61 offen lds
  s_lshl_b32 s60, s59, 7
  s_add_u32 s60, s60, s56
  s_mul_i32 s61, s59, s58
  s_add_u32 s61, s61, s57
  s_add_u32 s59, s59, 1
  s_cmp_eq_u32 s59, 9
  s_cselect_b32 s59, 0, s59
  s_add_u32 m0, s64, 110592
  s_nop 0
  buffer_load_dwordx4 v7, s[24:27], s60 offen lds
  s_add_u32 s60, s60, 9216
  s_add_u32 m0, s64, 111616
  s_nop 0
  buffer_load_dwordx4 v8, s[24:27], s60 offen lds
  s_add_u32 s60, s60, 9216
  s_add_u32 m0, s64, 112640
  s_nop 0
  buffer_load_dwordx4 v7, s[24:27], s60 offen lds
  s_add_u32 s60, s60, 9216
  s_add_u32 m0, s64, 113664
  s_nop 0
  buffer_load_dwordx4 v8, s[24:27], s60 offen lds
  s_add_u32 m0, s65, 126976
  s_nop 0
  buffer_load_dwordx4 v9, s[28:31], s61 offen lds
  s_waitcnt vmcnt(5)
  s_barrier
  s_add_u32 m0, s65, 131072
  s_nop 0
  buffer_load_dwordx4 v10, s[28:31], s61 offen lds
  s_add_u32 m0, s65, 135168
  s_nop 0
  buffer_load_dwordx4 v11, s[28:31], s61 offen lds
  s_add_u32 m0, s65, 139264
  s_nop 0
  buffer_load_dwordx4 v12, s[28:31], s61 offen lds
  s_add_u32 m0, s65, 143360
  s_nop 0
  buffer_load_dwordx4 v13, s[28:31], s61 offen lds
  s_lshl_b32 s60, s59, 7
  s_add_u32 s60, s60, s56
  s_mul_i32 s61, s59, s58
  s_add_u32 s61, s61, s57
  s_add_u32 s59, s59, 1
  s_cmp_eq_u32 s59, 9
  s_cselect_b32 s59, 0, s59
  s_add_u32 m0, s64, 0
  s_nop 0
  buffer_load_dwordx4 v7, s[24:27], s60 offen lds
  s_add_u32 s60, s60, 9216
  s_add_u32 m0, s64, 1024
  s_nop 0
  buffer_load_dwordx4 v8, s[24:27], s60 offen lds
  s_add_u32 s60, s60, 9216
  s_add_u32 m0, s64, 2048
  s_nop 0
  buffer_load_dwordx4 v7, s[24:27], s60 offen lds
  s_add_u32 s60, s60, 9216
  s_add_u32 m0, s64, 3072
  s_nop 0
  buffer_load_dwordx4 v8, s[24:27], s60 offen lds
  s_add_u32 m0, s65, 16384
  s_nop 0
  buffer_load_dwordx4 v9, s[28:31], s61 offen lds
  ds_read_b64_tr_b16 v[28:29], v26 offset:960
  ds_read_b64_tr_b16 v[30:31], v26 offset:1120
  ds_read_b64_tr_b16 v[32:33], v26 offset:1280
  ds_read_b64_tr_b16 v[34:35], v26 offset:1440
  ds_read_b64_tr_b16 v[36:37], v26 offset:1600
  ds_read_b64_tr_b16 v[38:39], v26 offset:1760
  ds_read_b64_tr_b16 v[40:41], v27 offset:992
  ds_read_b64_tr_b16 v[42:43], v27 offset:1152
  ds_read_b64_tr_b16 v[44:45], v27 offset:1312
  ds_read_b64_tr_b16 v[46:47], v27 offset:1472
  ds_read_b64_tr_b16 v[48:49], v27 offset:1632
  ds_read_b64_tr_b16 v[50:51], v27 offset:1792
  s_waitcnt vmcnt(5)
  s_barrier
  s_add_u32 m0, s65, 20480
  s_nop 0
  buffer_load_dwordx4 v10, s[28:31], s61 offen lds
  s_add_u32 m0, s65, 24576
  s_nop 0
  buffer_load_dwordx4 v11, s[28:31], s61 offen lds
  s_add_u32 m0, s65, 28672
  s_nop 0
  buffer_load_dwordx4 v12, s[28:31], s61 offen lds
  s_add_u32 m0, s65, 32768
  s_nop 0
  buffer_load_dwordx4 v13, s[28:31], s61 offen lds
  s_lshl_b32 s60, s59, 7
  s_add_u32 s60, s60, s56
  s_mul_i32 s61, s59, s58
  s_add_u32 s61, s61, s57
  s_add_u32 s59, s59, 1
  s_cmp_eq_u32 s59, 9
  s_cselect_b32 s59, 0, s59
  s_add_u32 m0, s64, 36864
  s_nop 0
  buffer_load_dwordx4 v7, s[24:27], s60 offen lds
  s_add_u32 s60, s60, 9216
  s_add_u32 m0, s64, 37888
  s_nop 0
  buffer_load_dwordx4 v8, s[24:27], s60 offen lds
  s_add_u32 s60, s60, 9216
  s_add_u32 m0, s64, 38912
  s_nop 0
  buffer_load_dwordx4 v7, s[24:27], s60 offen lds
  s_add_u32 s60, s60, 9216
  s_add_u32 m0, s64, 39936
  s_nop 0
  buffer_load_dwordx4 v8, s[24:27], s60 offen lds
  s_add_u32 m0, s65, 53248
  s_nop 0
  buffer_load_dwordx4 v9, s[28:31], s61 offen lds
  s_waitcnt vmcnt(5)
  s_barrier
  s_add_u32 m0, s65, 57344
  s_nop 0
  buffer_load_dwordx4 v10, s[28:31], s61 offen lds
  s_add_u32 m0, s65, 61440
  s_nop 0
  buffer_load_dwordx4 v11, s[28:31], s61 offen lds
  s_add_u32 m0, s65, 65536
  s_nop 0
  buffer_load_dwordx4 v12, s[28:31], s61 offen lds
  s_add_u32 m0, s65, 69632
  s_nop 0
  buffer_load_dwordx4 v13, s[28:31], s61 offen lds
  s_lshl_b32 s60, s59, 7
  s_add_u32 s60, s60, s56
  s_mul_i32 s61, s59, s58
  s_add_u32 s61, s61, s57
  s_add_u32 s59, s59, 1
  s_cmp_eq_u32 s59, 9
  s_cselect_b32 s59, 0, s59
  s_add_u32 m0, s64, 73728
  s_nop 0
  buffer_load_dwordx4 v7, s[24:27], s60 offen lds
  s_add_u32 s60, s60, 9216
  s_add_u32 m0, s64, 74752
  s_nop 0
  buffer_load_dwordx4 v8, s[24:27], s60 offen lds
  s_add_u32 s60, s60, 9216
  s_add_u32 m0, s64, 75776
  s_nop 0
  buffer_load_dwordx4 v7, s[24:27], s60 offen lds
  s_add_u32 s60, s60, 9216
  s_add_u32 m0, s64, 76800
  s_nop 0
  buffer_load_dwordx4 v8, s[24:27], s60 offen lds
  s_add_u32 m0, s65, 90112
  s_nop 0
  buffer_load_dwordx4 v9, s[28:31], s61 offen lds
  s_waitcnt vmcnt(5)
  s_barrier
  s_add_u32 m0, s65, 94208
  s_nop 0
  buffer_load_dwordx4 v10, s[28:31], s61 offen lds
  s_add_u32 m0, s65, 98304
  s_nop 0
  buffer_load_dwordx4 v11, s[28:31], s61 offen lds
  s_add_u32 m0, s65, 102400
  s_nop 0
  buffer_load_dwordx4 v12, s[28:31], s61 offen lds
  s_add_u32 m0, s65, 106496
  s_nop 0
  buffer_load_dwordx4 v13, s[28:31], s61 offen lds
  s_lshl_b32 s60, s59, 7
  s_add_u32 s60, s60, s56
  s_mul_i32 s61, s59, s58
  s_add_u32 s61, s61, s57
  s_add_u32 s59, s59, 1
  s_cmp_eq_u32 s59, 9
  s_cselect_b32 s59, 0, s59
  s_add_u32 m0, s64, 110592
  s_nop 0
  buffer_load_dwordx4 v7, s[24:27], s60 offen lds
  s_add_u32 s60, s60, 9216
  s_add_u32 m0, s64, 111616
  s_nop 0
  buffer_load_dwordx4 v8, s[24:27], s60 offen lds
  s_add_u32 s60, s60, 9216
  s_add_u32 m0, s64, 112640
  s_nop 0
  buffer_load_dwordx4 v7, s[24:27], s60 offen lds
  s_add_u32 s60, s60, 9216
  s_add_u32 m0, s64, 113664
  s_nop 0
  buffer_load_dwordx4 v8, s[24:27], s60 offen lds
  s_add_u32 m0, s65, 126976
  s_nop 0
  buffer_load_dwordx4 v9, s[28:31], s61 offen lds
  s_waitcnt vmcnt(5)
  s_barrier
  s_add_u32 m0, s65, 131072
  s_nop 0
  buffer_load_dwordx4 v10, s[28:31], s61 offen lds
  s_add_u32 m0, s65, 135168
  s_nop 0
  buffer_load_dwordx4 v11, s[28:31], s61 offen lds
  s_add_u32 m0, s65, 139264
  s_nop 0
  buffer_load_dwordx4 v12, s[28:31], s61 offen lds
  s_add_u32 m0, s65, 143360
  s_nop 0
  buffer_load_dwordx4 v13, s[28:31], s61 offen lds
  s_add_u32 m0, s70, 0
  s_nop 0
  buffer_load_dwordx4 v15, s[36:39], s69 offen lds
  s_add_u32 m0, s70, 1024
  s_nop 0
  buffer_load_dwordx4 v16, s[36:39], s69 offen lds
  s_add_u32 m0, s70, 2048
  s_nop 0
  buffer_load_dwordx4 v17, s[36:39], s69 offen lds
  s_add_u32 s69, s69, 73728
  s_add_u32 m0, s70, 12288
  s_nop 0
  buffer_load_dwordx4 v15, s[36:39], s69 offen lds
  s_add_u32 m0, s70, 13312
  s_nop 0
  buffer_load_dwordx4 v16, s[36:39], s69 offen lds
  s_waitcnt vmcnt(5)
  s_barrier
  s_add_u32 m0, s70, 14336
  s_nop 0
  buffer_load_dwordx4 v17, s[36:39], s69 offen lds
  s_add_u32 s69, s69, 73728
  s_add_u32 m0, s70, 24576
  s_nop 0
  buffer_load_dwordx4 v15, s[36:39], s69 offen lds
  s_add_u32 m0, s70, 25600
  s_nop 0
  buffer_load_dwordx4 v16, s[36:39], s69 offen lds
  s_add_u32 m0, s70, 26624
  s_nop 0
  buffer_load_dwordx4 v17, s[36:39], s69 offen lds
  s_add_u32 s69, s69, 73728
  s_add_u32 m0, s70, 36864
  s_nop 0
  buffer_load_dwordx4 v15, s[36:39], s69 offen lds
  s_add_u32 m0, s70, 37888
  s_nop 0
  buffer_load_dwordx4 v16, s[36:39], s69 offen lds
  s_add_u32 m0, s70, 38912
  s_nop 0
  buffer_load_dwordx4 v17, s[36:39], s69 offen lds
  s_add_u32 s69, s69, 73728
  s_add_u32 m0, s70, 49152
  s_nop 0
  buffer_load_dwordx4 v15, s[36:39], s69 offen lds
  s_add_u32 m0, s70, 50176
  s_nop 0
  buffer_load_dwordx4 v16, s[36:39], s69 offen lds
  s_add_u32 m0, s70, 51200
  s_nop 0
  buffer_load_dwordx4 v17, s[36:39], s69 offen lds
  s_add_u32 s69, s69, 73728
  s_cmp_lt_u32 s3, 16
  s_cbranch_scc1 L_kl2
  v_mov_b32 v254, 158624
  s_mov_b32 s68, 0
L_lf_3:
  ds_read_b128 v[68:71], v254 offset:48
  s_add_u32 s68, s68, 1
  s_cmp_gt_u32 s68, 1048576
  s_waitcnt lgkmcnt(0)
  v_min3_u32 v68, v68, v69, v70
  v_min_u32 v68, v68, v71
  v_cmp_eq_u32 vcc, 0, v68
  s_cbranch_scc1 L_lfd_4
  s_cbranch_vccz L_lfd_4
  s_sleep 1
  s_branch L_lf_3
L_lfd_4:
  buffer_store_dwordx4 v[20:23], v18, s[32:35], s73 offen sc1
  buffer_store_dwordx4 v[20:23], v18, s[32:35], s74 offen sc1
  buffer_store_dwordx4 v[20:23], v18, s[32:35], s75 offen sc1
  buffer_store_dwordx4 v[20:23], v19, s[32:35], s100 offen sc1
  buffer_store_dwordx4 v[20:23], v24, s[32:35], s101 offen sc1
  s_waitcnt vmcnt(0)
  s_mov_b64 exec, 3
  v_mov_b32 v255, s72
  buffer_store_dword v255, v25, s[32:35], 0 offen sc1
  s_mov_b64 exec, -1
  s_branch L_phis
L_kl2:
  buffer_store_dwordx4 v[20:23], v18, s[32:35], s73 offen sc1
  buffer_store_dwordx4 v[20:23], v18, s[32:35], s74 offen sc1
  buffer_store_dwordx4 v[20:23], v18, s[32:35], s75 offen sc1
  buffer_store_dwordx4 v[20:23], v19, s[32:35], s100 offen sc1
  buffer_store_dwordx4 v[20:23], v24, s[32:35], s101 offen sc1
  s_lshl_b32 s48, s44, 2
  s_add_u32 s48, s48, 158688
  v_mov_b32 v254, s48
  v_lshrrev_b32 v2, 2, v54
  s_mov_b32 s68, 0
  s_add_u32 s48, s64, 75776
  v_lshl_add_u32 v2, v1, 2, s48
L_kx_5:
  ds_read_b32 v68, v254
  s_add_u32 s68, s68, 1
  s_cmp_gt_u32 s68, 1048576
  s_waitcnt lgkmcnt(0)
  v_cmp_eq_u32 vcc, 0, v68
  s_cbranch_scc1 L_kxd_6
  s_cbranch_vccnz L_kx_5
L_kxd_6:
  s_setprio 2
  ds_read_b128 v[56:59], v54
  ds_read_b128 v[60:63], v54 offset:1024
  ds_read_b32 v64, v2
  s_waitcnt lgkmcnt(0)
  v_mfma_f32_32x32x16_bf16 v[72:87], v[28:31], v[56:59], 0
  v_mfma_f32_32x32x16_bf16 v[72:87], v[32:35], v[60:63], v[72:87]
  v_mfma_f32_32x32x16_bf16 v[72:87], v[36:39], v[64:67], v[72:87]
  v_mfma_f32_32x32x16_bf16 v[88:103], v[40:43], v[56:59], 0
  v_mfma_f32_32x32x16_bf16 v[88:103], v[44:47], v[60:63], v[88:103]
  v_mfma_f32_32x32x16_bf16 v[88:103], v[48:51], v[64:67], v[88:103]
  v_mov_b32 v254, 158624
  s_mov_b32 s68, 0
L_lf_7:
  ds_read_b128 v[68:71], v254 offset:32
  s_add_u32 s68, s68, 1
  s_cmp_gt_u32 s68, 1048576
  s_waitcnt lgkmcnt(0)
  v_min3_u32 v68, v68, v69, v70
  v_min_u32 v68, v68, v71
  v_cmp_eq_u32 vcc, 0, v68
  s_cbranch_scc1 L_lfd_8
  s_cbranch_vccnz L_lf_7
L_lfd_8:
  s_nop 8
  v_max3_f32 v122, v72, v73, v74
  v_min3_f32 v124, v72, v73, v74
  v_max3_f32 v122, v122, v75, v76
  v_min3_f32 v124, v124, v75, v76
  v_max3_f32 v122, v122, v77, v78
  v_min3_f32 v124, v124, v77, v78
  v_max3_f32 v122, v122, v79, v80
  v_min3_f32 v124, v124, v79, v80
  v_max3_f32 v122, v122, v81, v82
  v_min3_f32 v124, v124, v81, v82
  v_max3_f32 v122, v122, v83, v84
  v_min3_f32 v124, v124, v83, v84
  v_max3_f32 v122, v122, v85, v86
  v_min3_f32 v124, v124, v85, v86
  v_max3_f32 v122, v122, v87, v88
  v_min3_f32 v124, v124, v87, v88
  v_max_f32 v122, v122, v89
  v_min_f32 v124, v124, v89
  v_mul_f32 v123, s46, v122
  v_mul_f32 v125, s46, v124
  v_mul_f32 v122, s46, v122
  v_mul_f32 v124, s46, v124
  v_pk_fma_f32 v[126:127], v[72:73], s[46:47], v[122:123] neg_lo:[0,0,1] neg_hi:[0,0,1]
  v_pk_fma_f32 v[144:145], v[72:73], s[46:47], v[124:125] neg_lo:[1,0,0] neg_hi:[1,0,0]
  v_pk_fma_f32 v[128:129], v[74:75], s[46:47], v[122:123] neg_lo:[0,0,1] neg_hi:[0,0,1]
  v_pk_fma_f32 v[146:147], v[74:75], s[46:47], v[124:125] neg_lo:[1,0,0] neg_hi:[1,0,0]
  v_pk_fma_f32 v[130:131], v[76:77], s[46:47], v[122:123] neg_lo:[0,0,1] neg_hi:[0,0,1]
  v_pk_fma_f32 v[148:149], v[76:77], s[46:47], v[124:125] neg_lo:[1,0,0] neg_hi:[1,0,0]
  v_pk_fma_f32 v[132:133], v[78:79], s[46:47], v[122:123] neg_lo:[0,0,1] neg_hi:[0,0,1]
  v_pk_fma_f32 v[150:151], v[78:79], s[46:47], v[124:125] neg_lo:[1,0,0] neg_hi:[1,0,0]
  v_pk_fma_f32 v[134:135], v[80:81], s[46:47], v[122:123] neg_lo:[0,0,1] neg_hi:[0,0,1]
  v_pk_fma_f32 v[152:153], v[80:81], s[46:47], v[124:125] neg_lo:[1,0,0] neg_hi:[1,0,0]
  v_pk_fma_f32 v[136:137], v[82:83], s[46:47], v[122:123] neg_lo:[0,0,1] neg_hi:[0,0,1]
  v_pk_fma_f32 v[154:155], v[82:83], s[46:47], v[124:125] neg_lo:[1,0,0] neg_hi:[1,0,0]
  v_pk_fma_f32 v[138:139], v[84:85], s[46:47], v[122:123] neg_lo:[0,0,1] neg_hi:[0,0,1]
  v_pk_fma_f32 v[156:157], v[84:85], s[46:47], v[124:125] neg_lo:[1,0,0] neg_hi:[1,0,0]
  v_pk_fma_f32 v[140:141], v[86:87], s[46:47], v[122:123] neg_lo:[0,0,1] neg_hi:[0,0,1]
  v_pk_fma_f32 v[158:159], v[86:87], s[46:47], v[124:125] neg_lo:[1,0,0] neg_hi:[1,0,0]
  v_pk_fma_f32 v[142:143], v[88:89], s[46:47], v[122:123] neg_lo:[0,0,1] neg_hi:[0,0,1]
  v_pk_fma_f32 v[160:161], v[88:89], s[46:47], v[124:125] neg_lo:[1,0,0] neg_hi:[1,0,0]
  v_exp_f32 v126, v126
  v_exp_f32 v144, v144
  v_exp_f32 v127, v127
  v_exp_f32 v145, v145
  v_exp_f32 v128, v128
  v_exp_f32 v146, v146
  v_exp_f32 v129, v129
  v_exp_f32 v147, v147
  v_exp_f32 v130, v130
  v_exp_f32 v148, v148
  v_exp_f32 v131, v131
  v_exp_f32 v149, v149
  v_exp_f32 v132, v132
  v_exp_f32 v150, v150
  v_exp_f32 v133, v133
  v_exp_f32 v151, v151
  v_exp_f32 v134, v134
  v_exp_f32 v152, v152
  v_exp_f32 v135, v135
  v_exp_f32 v153, v153
  v_exp_f32 v136, v136
  v_exp_f32 v154, v154
  v_exp_f32 v137, v137
  v_exp_f32 v155, v155
  v_exp_f32 v138, v138
  v_exp_f32 v156, v156
  v_exp_f32 v139, v139
  v_exp_f32 v157, v157
  v_exp_f32 v140, v140
  v_exp_f32 v158, v158
  v_exp_f32 v141, v141
  v_exp_f32 v159, v159
  v_exp_f32 v142, v142
  v_exp_f32 v160, v160
  v_exp_f32 v143, v143
  v_exp_f32 v161, v161
  v_pk_add_f32 v[162:163], v[126:127], v[128:129]
  v_pk_add_f32 v[164:165], v[144:145], v[146:147]
  v_pk_add_f32 v[162:163], v[162:163], v[130:131]
  v_pk_add_f32 v[164:165], v[164:165], v[148:149]
  v_pk_add_f32 v[162:163], v[162:163], v[132:133]
  v_pk_add_f32 v[164:165], v[164:165], v[150:151]
  v_pk_add_f32 v[162:163], v[162:163], v[134:135]
  v_pk_add_f32 v[164:165], v[164:165], v[152:153]
  v_pk_add_f32 v[162:163], v[162:163], v[136:137]
  v_pk_add_f32 v[164:165], v[164:165], v[154:155]
  v_pk_add_f32 v[162:163], v[162:163], v[138:139]
  v_pk_add_f32 v[164:165], v[164:165], v[156:157]
  v_pk_add_f32 v[162:163], v[162:163], v[140:141]
  v_pk_add_f32 v[164:165], v[164:165], v[158:159]
  v_pk_add_f32 v[162:163], v[162:163], v[142:143]
  v_pk_add_f32 v[164:165], v[164:165], v[160:161]
  v_add_f32 v162, v162, v163
  v_add_f32 v164, v164, v165
  v_rcp_f32 v162, v162
  v_rcp_f32 v164, v164
  v_mov_b32 v163, v162
  v_mov_b32 v165, v164
  v_pk_mul_f32 v[126:127], v[126:127], v[162:163]
  v_pk_mul_f32 v[128:129], v[128:129], v[162:163]
  v_pk_mul_f32 v[130:131], v[130:131], v[162:163]
  v_cvt_pk_bf16_f32 v104, v126, v127
  v_pk_mul_f32 v[132:133], v[132:133], v[162:163]
  v_cvt_pk_bf16_f32 v105, v128, v129
  ds_write_b64 v53, v[104:105] offset:72
  v_pk_mul_f32 v[134:135], v[134:135], v[162:163]
  v_cvt_pk_bf16_f32 v106, v130, v131
  v_pk_mul_f32 v[136:137], v[136:137], v[162:163]
  v_cvt_pk_bf16_f32 v107, v132, v133
  v_pk_mul_f32 v[138:139], v[138:139], v[162:163]
  v_cvt_pk_bf16_f32 v108, v134, v135
  v_pk_mul_f32 v[140:141], v[140:141], v[162:163]
  v_cvt_pk_bf16_f32 v109, v136, v137
  ds_write_b128 v53, v[106:109] offset:80
  v_pk_mul_f32 v[142:143], v[142:143], v[162:163]
  v_cvt_pk_bf16_f32 v110, v138, v139
  v_cvt_pk_bf16_f32 v111, v140, v141
  v_cvt_pk_bf16_f32 v112, v142, v143
  v_pk_mul_f32 v[144:145], v[144:145], v[164:165]
  v_pk_mul_f32 v[146:147], v[146:147], v[164:165]
  v_pk_mul_f32 v[148:149], v[148:149], v[164:165]
  v_cvt_pk_bf16_f32 v113, v144, v145
  ds_write_b128 v53, v[110:113] offset:96
  v_pk_mul_f32 v[150:151], v[150:151], v[164:165]
  v_cvt_pk_bf16_f32 v114, v146, v147
  v_pk_mul_f32 v[152:153], v[152:153], v[164:165]
  v_cvt_pk_bf16_f32 v115, v148, v149
  v_pk_mul_f32 v[154:155], v[154:155], v[164:165]
  v_cvt_pk_bf16_f32 v116, v150, v151
  v_pk_mul_f32 v[156:157], v[156:157], v[164:165]
  v_cvt_pk_bf16_f32 v117, v152, v153
  ds_write_b128 v53, v[114:117] offset:112
  v_pk_mul_f32 v[158:159], v[158:159], v[164:165]
  v_cvt_pk_bf16_f32 v118, v154, v155
  v_pk_mul_f32 v[160:161], v[160:161], v[164:165]
  v_cvt_pk_bf16_f32 v119, v156, v157
  v_cvt_pk_bf16_f32 v120, v158, v159
  v_cvt_pk_bf16_f32 v121, v160, v161
  ds_write_b128 v53, v[118:121] offset:128
  s_waitcnt vmcnt(0)
  s_lshl_b32 s48, s44, 2
  s_add_u32 s48, s48, 158640
  v_mov_b32 v254, s48
  v_mov_b32 v255, 1
  ds_write_b32 v254, v255
  s_setprio 0
  s_mov_b64 exec, 3
  v_mov_b32 v255, s72
  buffer_store_dword v255, v25, s[32:35], 0 offen sc1
  s_mov_b64 exec, -1
  s_branch L_phis
L_c:
  v_and_b32 v2, 15, v1
  v_lshrrev_b32 v3, 4, v1
  v_bfe_u32 v4, v1, 1, 3
  v_xor_b32 v3, v3, v4
  v_lshlrev_b32 v2, 7, v2
  v_lshl_add_u32 v7, v3, 4, v2
  v_xor_b32 v8, 64, v7
  s_cmp_ge_u32 s3, 24
  s_cbranch_scc1 L_bc
  s_setprio 1
  v_add_u32 v7, s64, v7
  v_add_u32 v8, s64, v8
  v_lshrrev_b32 v2, 5, v1
  v_bfe_u32 v3, v1, 2, 3
  v_lshl_add_u32 v2, v2, 4, v3
  v_mul_u32_u24 v2, 288, v2
  v_and_b32 v3, 1, v1
  v_mul_u32_u24 v3, 144, v3
  v_bfe_u32 v4, v1, 1, 1
  v_mul_u32_u24 v4, 72, v4
  v_add3_u32 v9, v2, v3, v4
  v_add_u32 v9, 16384, v9
  v_mov_b32 v2, 0
  v_mov_b32 v3, 0
  v_lshlrev_b32 v4, 3, v6
  v_add_u32 v4, 154624, v4
  ds_write_b64 v4, v[2:3]
  ds_write_b64 v4, v[2:3] offset:2048
  ds_write_b64 v4, v[2:3] offset:4096
  s_mov_b32 s46, 1069066811
  s_mov_b32 s47, 1069066811
  s_lshl_b32 s66, s45, 1
  s_and_b32 s48, s3, 1
  s_add_u32 s66, s66, s48
  s_lshr_b32 s48, s3, 1
  s_and_b32 s49, s3, 0x1e
  s_sub_u32 s49, s49, 8
  s_add_u32 s49, s49, s71
  s_cmp_lt_u32 s3, 16
  s_cselect_b32 s67, s48, s49
  s_waitcnt lgkmcnt(0)
  s_add_u32 s52, s14, 3383296
  s_addc_u32 s53, s15, 0
  s_load_dword s72, s[52:53], 0
  s_mov_b32 s36, s8
  s_and_b32 s37, s9, 0xffff
  s_mov_b32 s38, 20736
  s_mov_b32 s39, 0x20000
  s_mov_b32 s32, s14
  s_and_b32 s33, s15, 0xffff
  s_mov_b32 s34, 9437184
  s_mov_b32 s35, 0x20000
  s_lshl_b32 s54, s63, 2
  s_mul_i32 s48, s54, 648
  v_add_u32 v13, 0, v6
  v_mul_u32_u24 v14, 205, v13
  v_lshrrev_b32 v14, 11, v14
  v_mul_u32_u24 v15, 10, v14
  v_sub_u32 v13, v13, v15
  v_mul_u32_u24 v15, 43, v14
  v_lshrrev_b32 v15, 10, v15
  v_mul_u32_u24 v16, 24, v15
  v_sub_u32 v14, v14, v16
  v_mul_u32_u24 v15, 648, v15
  v_mad_u32_u24 v15, v14, 36, v15
  v_lshl_add_u32 v15, v13, 2, v15
  v_cmp_gt_u32 vcc, 18, v14
  v_cmp_gt_u32 s[50:51], 9, v13
  s_nop 0
  s_and_b64 vcc, vcc, s[50:51]
  v_mov_b32 v16, 1073741824
  v_cndmask_b32 v15, v16, v15, vcc
  s_lshl_b32 s49, s44, 8
  s_add_u32 m0, s49, 148480
  s_nop 0
  buffer_load_dword v15, s[36:39], s48 offen lds
  v_add_u32 v13, 256, v6
  v_mul_u32_u24 v14, 205, v13
  v_lshrrev_b32 v14, 11, v14
  v_mul_u32_u24 v15, 10, v14
  v_sub_u32 v13, v13, v15
  v_mul_u32_u24 v15, 43, v14
  v_lshrrev_b32 v15, 10, v15
  v_mul_u32_u24 v16, 24, v15
  v_sub_u32 v14, v14, v16
  v_mul_u32_u24 v15, 648, v15
  v_mad_u32_u24 v15, v14, 36, v15
  v_lshl_add_u32 v15, v13, 2, v15
  v_cmp_gt_u32 vcc, 18, v14
  v_cmp_gt_u32 s[50:51], 9, v13
  s_nop 0
  s_and_b64 vcc, vcc, s[50:51]
  v_mov_b32 v16, 1073741824
  v_cndmask_b32 v15, v16, v15, vcc
  s_lshl_b32 s49, s44, 8
  s_add_u32 m0, s49, 149504
  s_nop 0
  buffer_load_dword v15, s[36:39], s48 offen lds
  v_add_u32 v13, 512, v6
  v_mul_u32_u24 v14, 205, v13
  v_lshrrev_b32 v14, 11, v14
  v_mul_u32_u24 v15, 10, v14
  v_sub_u32 v13, v13, v15
  v_mul_u32_u24 v15, 43, v14
  v_lshrrev_b32 v15, 10, v15
  v_mul_u32_u24 v16, 24, v15
  v_sub_u32 v14, v14, v16
  v_mul_u32_u24 v15, 648, v15
  v_mad_u32_u24 v15, v14, 36, v15
  v_lshl_add_u32 v15, v13, 2, v15
  v_cmp_gt_u32 vcc, 18, v14
  v_cmp_gt_u32 s[50:51], 9, v13
  s_nop 0
  s_and_b64 vcc, vcc, s[50:51]
  v_mov_b32 v16, 1073741824
  v_cndmask_b32 v15, v16, v15, vcc
  s_lshl_b32 s49, s44, 8
  s_add_u32 m0, s49, 150528
  s_nop 0
  buffer_load_dword v15, s[36:39], s48 offen lds
  v_add_u32 v13, 768, v6
  v_mul_u32_u24 v14, 205, v13
  v_lshrrev_b32 v14, 11, v14
  v_mul_u32_u24 v15, 10, v14
  v_sub_u32 v13, v13, v15
  v_mul_u32_u24 v15, 43, v14
  v_lshrrev_b32 v15, 10, v15
  v_mul_u32_u24 v16, 24, v15
  v_sub_u32 v14, v14, v16
  v_mul_u32_u24 v15, 648, v15
  v_mad_u32_u24 v15, v14, 36, v15
  v_lshl_add_u32 v15, v13, 2, v15
  v_cmp_gt_u32 vcc, 18, v14
  v_cmp_gt_u32 s[50:51], 9, v13
  s_nop 0
  s_and_b64 vcc, vcc, s[50:51]
  v_mov_b32 v16, 1073741824
  v_cndmask_b32 v15, v16, v15, vcc
  s_lshl_b32 s49, s44, 8
  s_add_u32 m0, s49, 151552
  s_nop 0
  buffer_load_dword v15, s[36:39], s48 offen lds
  s_lshl_b32 s54, s66, 1
  s_mul_i32 s48, s54, 648
  v_add_u32 v13, 0, v6
  v_mul_u32_u24 v14, 205, v13
  v_lshrrev_b32 v14, 11, v14
  v_mul_u32_u24 v15, 10, v14
  v_sub_u32 v13, v13, v15
  v_mul_u32_u24 v15, 43, v14
  v_lshrrev_b32 v15, 10, v15
  v_mul_u32_u24 v16, 24, v15
  v_sub_u32 v14, v14, v16
  v_mul_u32_u24 v15, 648, v15
  v_mad_u32_u24 v15, v14, 36, v15
  v_lshl_add_u32 v15, v13, 2, v15
  v_cmp_gt_u32 vcc, 18, v14
  v_cmp_gt_u32 s[50:51], 9, v13
  s_nop 0
  s_and_b64 vcc, vcc, s[50:51]
  v_mov_b32 v16, 1073741824
  v_cndmask_b32 v15, v16, v15, vcc
  s_lshl_b32 s49, s44, 8
  s_add_u32 m0, s49, 152576
  s_nop 0
  buffer_load_dword v15, s[36:39], s48 offen lds
  v_add_u32 v13, 256, v6
  v_mul_u32_u24 v14, 205, v13
  v_lshrrev_b32 v14, 11, v14
  v_mul_u32_u24 v15, 10, v14
  v_sub_u32 v13, v13, v15
  v_mul_u32_u24 v15, 43, v14
  v_lshrrev_b32 v15, 10, v15
  v_mul_u32_u24 v16, 24, v15
  v_sub_u32 v14, v14, v16
  v_mul_u32_u24 v15, 648, v15
  v_mad_u32_u24 v15, v14, 36, v15
  v_lshl_add_u32 v15, v13, 2, v15
  v_cmp_gt_u32 vcc, 18, v14
  v_cmp_gt_u32 s[50:51], 9, v13
  s_nop 0
  s_and_b64 vcc, vcc, s[50:51]
  v_mov_b32 v16, 1073741824
  v_cndmask_b32 v15, v16, v15, vcc
  s_lshl_b32 s49, s44, 8
  s_add_u32 m0, s49, 153600
  s_nop 0
  buffer_load_dword v15, s[36:39], s48 offen lds
  s_add_u32 s48, s64, 73728
  v_lshl_add_u32 v40, v1, 4, s48
  s_add_u32 s48, s64, 75776
  v_lshl_add_u32 v41, v1, 2, s48
  v_and_b32 v15, 1, v1
  v_lshrrev_b32 v13, 5, v1
  v_cmp_eq_u32 vcc, v15, v13
  v_mul_u32_u24 v14, 1920, v15
  v_bfe_u32 v15, v1, 2, 2
  v_mad_u32_u24 v14, v15, 40, v14
  v_add_u32 v14, 148480, v14
  v_mov_b32 v15, 158720
  v_cndmask_b32 v14, v15, v14, vcc
  v_bfe_u32 v15, v1, 4, 1
  v_lshl_add_u32 v13, v15, 4, v14
  v_bfe_u32 v15, v1, 1, 1
  v_lshl_add_u32 v13, v15, 3, v13
  v_and_b32 v2, 31, v1
  s_lshl_b32 s48, s44, 5
  v_add_u32 v2, s48, v2
  v_mul_u32_u24 v2, 464, v2
  v_lshrrev_b32 v3, 5, v1
  v_mul_u32_u24 v3, 224, v3
  v_add_u32 v42, v2, v3
  v_add_u32 v42, 89088, v42
  v_bfe_u32 v3, v1, 2, 3
  v_lshrrev_b32 v4, 5, v1
  v_lshl_add_u32 v3, v4, 3, v3
  v_mul_u32_u24 v3, 928, v3
  v_and_b32 v4, 3, v1
  v_lshl_add_u32 v3, v4, 3, v3
  s_lshr_b32 s48, s44, 1
  s_mul_i32 s48, s48, 224
  s_add_u32 s48, s48, 89088
  s_and_b32 s49, s44, 1
  s_mul_i32 s50, s49, 72
  s_add_u32 s50, s50, s48
  s_mul_i32 s49, s49, 40
  s_add_u32 s49, s49, s48
  s_add_u32 s49, s49, 144
  v_add_u32 v44, s49, v3
  v_add_u32 v43, s50, v3
  v_and_b32 v2, 15, v1
  v_lshrrev_b32 v3, 4, v1
  v_lshlrev_b32 v45, 4, v1
  v_lshl_add_u32 v4, v3, 2, v2
  v_lshlrev_b32 v4, 4, v4
  v_mov_b32 v5, 1073741824
  v_cmp_gt_u32 vcc, 4, v2
  s_nop 1
  v_cndmask_b32 v46, v5, v4, vcc
  v_lshlrev_b32 v4, 3, v1
  v_cmp_gt_u32 vcc, 16, v1
  s_nop 1
  v_cndmask_b32 v47, v5, v4, vcc
  v_cmp_gt_u32 vcc, 4, v1
  s_nop 1
  v_cndmask_b32 v48, v5, v4, vcc
  s_lshl_b32 s48, s63, 1
  s_lshr_b32 s49, s44, 1
  s_add_u32 s48, s48, s49
  s_lshl_b32 s48, s48, 4
  s_add_u32 s48, s48, s62
  s_lshl_b32 s48, s48, 1
  s_and_b32 s49, s44, 1
  s_add_u32 s48, s48, s49
  s_mul_i32 s56, s48, 1536
  s_add_u32 s56, s56, 0
  s_cmp_lt_u32 s3, 16
  s_cbranch_scc1 L_qpre_9
  v_bfe_u32 v2, v1, 4, 1
  v_lshrrev_b32 v3, 5, v1
  v_lshl_add_u32 v2, v2, 1, v3
  v_mul_u32_u24 v2, 9216, v2
  v_and_b32 v3, 15, v1
  v_lshl_add_u32 v43, v3, 4, v2
  v_lshl_add_u32 v44, v3, 2, v2
  s_lshl_b32 s48, s62, 4
  s_lshl_b32 s49, s63, 2
  s_add_u32 s48, s48, s49
  s_lshl_b32 s48, s48, 2
  s_add_u32 s48, s48, s44
  s_mul_i32 s48, s48, 2304
  s_add_u32 s56, s48, 4194304
L_qpre_9:
  s_waitcnt lgkmcnt(0)
  s_add_u32 s72, s72, 1
  s_barrier
  v_add_u32 v10, 110592, v7
  v_add_u32 v12, 110592, v9
  v_add_u32 v11, 110592, v8
  ds_read_b128 v[124:127], v10 offset:0
  ds_read_b128 v[128:131], v10 offset:2048
  ds_read_b64_tr_b16 v[140:141], v12 offset:0
  ds_read_b64_tr_b16 v[142:143], v12 offset:2304
  ds_read_b64_tr_b16 v[144:145], v12 offset:8
  ds_read_b64_tr_b16 v[146:147], v12 offset:2312
  ds_read_b64_tr_b16 v[148:149], v12 offset:16
  ds_read_b64_tr_b16 v[150:151], v12 offset:2320
  ds_read_b64_tr_b16 v[152:153], v12 offset:24
  ds_read_b64_tr_b16 v[154:155], v12 offset:2328
  ds_read_b64_tr_b16 v[156:157], v12 offset:32
  ds_read_b64_tr_b16 v[158:159], v12 offset:2336
  ds_read_b64_tr_b16 v[160:161], v12 offset:40
  ds_read_b64_tr_b16 v[162:163], v12 offset:2344
  s_waitcnt lgkmcnt(10)
  v_mfma_f32_16x16x32_bf16 v[52:55], v[140:143], v[124:127], 0
  ds_read_b64_tr_b16 v[164:165], v12 offset:48
  ds_read_b64_tr_b16 v[166:167], v12 offset:2352
  ds_read_b64_tr_b16 v[168:169], v12 offset:56
  v_mfma_f32_16x16x32_bf16 v[88:91], v[140:143], v[128:131], 0
  s_waitcnt lgkmcnt(11)
  v_mfma_f32_16x16x32_bf16 v[56:59], v[144:147], v[124:127], 0
  ds_read_b64_tr_b16 v[170:171], v12 offset:2360
  ds_read_b64_tr_b16 v[172:173], v12 offset:64
  v_mfma_f32_16x16x32_bf16 v[92:95], v[144:147], v[128:131], 0
  s_waitcnt lgkmcnt(11)
  v_mfma_f32_16x16x32_bf16 v[60:63], v[148:151], v[124:127], 0
  ds_read_b64_tr_b16 v[174:175], v12 offset:2368
  v_mfma_f32_16x16x32_bf16 v[96:99], v[148:151], v[128:131], 0
  ds_read_b128 v[132:135], v11 offset:0
  ds_read_b128 v[136:139], v11 offset:2048
  s_waitcnt lgkmcnt(12)
  v_mfma_f32_16x16x32_bf16 v[64:67], v[152:155], v[124:127], 0
  ds_read_b64_tr_b16 v[176:177], v12 offset:9216
  ds_read_b64_tr_b16 v[178:179], v12 offset:11520
  v_mfma_f32_16x16x32_bf16 v[100:103], v[152:155], v[128:131], 0
  ds_read_b64_tr_b16 v[180:181], v12 offset:9224
  s_waitcnt lgkmcnt(10)
  ds_read_b64_tr_b16 v[182:183], v12 offset:11528
  v_mfma_f32_16x16x32_bf16 v[68:71], v[156:159], v[124:127], 0
  ds_read_b64_tr_b16 v[184:185], v12 offset:9232
  ds_read_b64_tr_b16 v[186:187], v12 offset:11536
  v_mfma_f32_16x16x32_bf16 v[104:107], v[156:159], v[128:131], 0
  ds_read_b64_tr_b16 v[188:189], v12 offset:9240
  ds_read_b64_tr_b16 v[190:191], v12 offset:11544
  v_mfma_f32_16x16x32_bf16 v[72:75], v[160:163], v[124:127], 0
  s_waitcnt lgkmcnt(10)
  ds_read_b64_tr_b16 v[192:193], v12 offset:9248
  ds_read_b64_tr_b16 v[194:195], v12 offset:11552
  v_mfma_f32_16x16x32_bf16 v[108:111], v[160:163], v[128:131], 0
  ds_read_b64_tr_b16 v[196:197], v12 offset:9256
  ds_read_b64_tr_b16 v[198:199], v12 offset:11560
  v_mfma_f32_16x16x32_bf16 v[76:79], v[164:167], v[124:127], 0
  ds_read_b64_tr_b16 v[200:201], v12 offset:9264
  v_mfma_f32_16x16x32_bf16 v[112:115], v[164:167], v[128:131], 0
  s_waitcnt lgkmcnt(10)
  ds_read_b64_tr_b16 v[202:203], v12 offset:11568
  v_mfma_f32_16x16x32_bf16 v[80:83], v[168:171], v[124:127], 0
  ds_read_b64_tr_b16 v[204:205], v12 offset:9272
  v_mfma_f32_16x16x32_bf16 v[116:119], v[168:171], v[128:131], 0
  ds_read_b64_tr_b16 v[206:207], v12 offset:11576
  v_mfma_f32_16x16x32_bf16 v[84:87], v[172:175], v[124:127], 0
  ds_read_b64_tr_b16 v[208:209], v12 offset:9280
  v_mfma_f32_16x16x32_bf16 v[120:123], v[172:175], v[128:131], 0
  ds_read_b64_tr_b16 v[210:211], v12 offset:11584
  v_mfma_f32_16x16x32_bf16 v[52:55], v[176:179], v[132:135], v[52:55]
  v_mfma_f32_16x16x32_bf16 v[88:91], v[176:179], v[136:139], v[88:91]
  s_waitcnt vmcnt(0)
  s_barrier
  s_waitcnt lgkmcnt(10)
  v_add_u32 v10, 0, v7
  v_add_u32 v12, 0, v9
  v_add_u32 v11, 0, v8
  ds_read_b128 v[124:127], v10 offset:0
  ds_read_b128 v[128:131], v10 offset:2048
  v_mfma_f32_16x16x32_bf16 v[56:59], v[180:183], v[132:135], v[56:59]
  ds_read_b64_tr_b16 v[140:141], v12 offset:0
  ds_read_b64_tr_b16 v[142:143], v12 offset:2304
  v_mfma_f32_16x16x32_bf16 v[92:95], v[180:183], v[136:139], v[92:95]
  ds_read_b64_tr_b16 v[144:145], v12 offset:8
  s_waitcnt lgkmcnt(10)
  ds_read_b64_tr_b16 v[146:147], v12 offset:2312
  v_mfma_f32_16x16x32_bf16 v[60:63], v[184:187], v[132:135], v[60:63]
  ds_read_b64_tr_b16 v[148:149], v12 offset:16
  v_mfma_f32_16x16x32_bf16 v[96:99], v[184:187], v[136:139], v[96:99]
  ds_read_b64_tr_b16 v[150:151], v12 offset:2320
  v_mfma_f32_16x16x32_bf16 v[64:67], v[188:191], v[132:135], v[64:67]
  ds_read_b64_tr_b16 v[152:153], v12 offset:24
  v_mfma_f32_16x16x32_bf16 v[100:103], v[188:191], v[136:139], v[100:103]
  ds_read_b64_tr_b16 v[154:155], v12 offset:2328
  v_mfma_f32_16x16x32_bf16 v[68:71], v[192:195], v[132:135], v[68:71]
  s_waitcnt lgkmcnt(10)
  ds_read_b64_tr_b16 v[156:157], v12 offset:32
  v_mfma_f32_16x16x32_bf16 v[104:107], v[192:195], v[136:139], v[104:107]
  ds_read_b64_tr_b16 v[158:159], v12 offset:2336
  v_mfma_f32_16x16x32_bf16 v[72:75], v[196:199], v[132:135], v[72:75]
  ds_read_b64_tr_b16 v[160:161], v12 offset:40
  v_mfma_f32_16x16x32_bf16 v[108:111], v[196:199], v[136:139], v[108:111]
  ds_read_b64_tr_b16 v[162:163], v12 offset:2344
  v_mfma_f32_16x16x32_bf16 v[76:79], v[200:203], v[132:135], v[76:79]
  ds_read_b64_tr_b16 v[164:165], v12 offset:48
  v_mfma_f32_16x16x32_bf16 v[112:115], v[200:203], v[136:139], v[112:115]
  s_waitcnt lgkmcnt(10)
  ds_read_b64_tr_b16 v[166:167], v12 offset:2352
  v_mfma_f32_16x16x32_bf16 v[80:83], v[204:207], v[132:135], v[80:83]
  ds_read_b64_tr_b16 v[168:169], v12 offset:56
  v_mfma_f32_16x16x32_bf16 v[116:119], v[204:207], v[136:139], v[116:119]
  ds_read_b64_tr_b16 v[170:171], v12 offset:2360
  v_mfma_f32_16x16x32_bf16 v[84:87], v[208:211], v[132:135], v[84:87]
  ds_read_b64_tr_b16 v[172:173], v12 offset:64
  v_mfma_f32_16x16x32_bf16 v[120:123], v[208:211], v[136:139], v[120:123]
  ds_read_b64_tr_b16 v[174:175], v12 offset:2368
  v_mfma_f32_16x16x32_bf16 v[52:55], v[140:143], v[124:127], v[52:55]
  s_waitcnt lgkmcnt(10)
  ds_read_b128 v[132:135], v11 offset:0
  ds_read_b128 v[136:139], v11 offset:2048
  v_mfma_f32_16x16x32_bf16 v[88:91], v[140:143], v[128:131], v[88:91]
  ds_read_b64_tr_b16 v[176:177], v12 offset:9216
  ds_read_b64_tr_b16 v[178:179], v12 offset:11520
  v_mfma_f32_16x16x32_bf16 v[56:59], v[144:147], v[124:127], v[56:59]
  ds_read_b64_tr_b16 v[180:181], v12 offset:9224
  v_mfma_f32_16x16x32_bf16 v[92:95], v[144:147], v[128:131], v[92:95]
  s_waitcnt lgkmcnt(10)
  ds_read_b64_tr_b16 v[182:183], v12 offset:11528
  v_mfma_f32_16x16x32_bf16 v[60:63], v[148:151], v[124:127], v[60:63]
  ds_read_b64_tr_b16 v[184:185], v12 offset:9232
  v_mfma_f32_16x16x32_bf16 v[96:99], v[148:151], v[128:131], v[96:99]
  ds_read_b64_tr_b16 v[186:187], v12 offset:11536
  v_mfma_f32_16x16x32_bf16 v[64:67], v[152:155], v[124:127], v[64:67]
  ds_read_b64_tr_b16 v[188:189], v12 offset:9240
  v_mfma_f32_16x16x32_bf16 v[100:103], v[152:155], v[128:131], v[100:103]
  ds_read_b64_tr_b16 v[190:191], v12 offset:11544
  v_mfma_f32_16x16x32_bf16 v[68:71], v[156:159], v[124:127], v[68:71]
  s_waitcnt lgkmcnt(10)
  ds_read_b64_tr_b16 v[192:193], v12 offset:9248
  v_mfma_f32_16x16x32_bf16 v[104:107], v[156:159], v[128:131], v[104:107]
  ds_read_b64_tr_b16 v[194:195], v12 offset:11552
  v_mfma_f32_16x16x32_bf16 v[72:75], v[160:163], v[124:127], v[72:75]
  ds_read_b64_tr_b16 v[196:197], v12 offset:9256
  v_mfma_f32_16x16x32_bf16 v[108:111], v[160:163], v[128:131], v[108:111]
  ds_read_b64_tr_b16 v[198:199], v12 offset:11560
  v_mfma_f32_16x16x32_bf16 v[76:79], v[164:167], v[124:127], v[76:79]
  ds_read_b64_tr_b16 v[200:201], v12 offset:9264
  v_mfma_f32_16x16x32_bf16 v[112:115], v[164:167], v[128:131], v[112:115]
  s_waitcnt lgkmcnt(10)
  ds_read_b64_tr_b16 v[202:203], v12 offset:11568
  v_mfma_f32_16x16x32_bf16 v[80:83], v[168:171], v[124:127], v[80:83]
  ds_read_b64_tr_b16 v[204:205], v12 offset:9272
  v_mfma_f32_16x16x32_bf16 v[116:119], v[168:171], v[128:131], v[116:119]
  ds_read_b64_tr_b16 v[206:207], v12 offset:11576
  v_mfma_f32_16x16x32_bf16 v[84:87], v[172:175], v[124:127], v[84:87]
  ds_read_b64_tr_b16 v[208:209], v12 offset:9280
  v_mfma_f32_16x16x32_bf16 v[120:123], v[172:175], v[128:131], v[120:123]
  ds_read_b64_tr_b16 v[210:211], v12 offset:11584
  v_mfma_f32_16x16x32_bf16 v[52:55], v[176:179], v[132:135], v[52:55]
  v_mfma_f32_16x16x32_bf16 v[88:91], v[176:179], v[136:139], v[88:91]
  s_barrier
  s_waitcnt lgkmcnt(10)
  v_add_u32 v10, 36864, v7
  v_add_u32 v12, 36864, v9
  v_add_u32 v11, 36864, v8
  ds_read_b128 v[124:127], v10 offset:0
  ds_read_b128 v[128:131], v10 offset:2048
  v_mfma_f32_16x16x32_bf16 v[56:59], v[180:183], v[132:135], v[56:59]
  ds_read_b64_tr_b16 v[140:141], v12 offset:0
  ds_read_b64_tr_b16 v[142:143], v12 offset:2304
  v_mfma_f32_16x16x32_bf16 v[92:95], v[180:183], v[136:139], v[92:95]
  ds_read_b64_tr_b16 v[144:145], v12 offset:8
  s_waitcnt lgkmcnt(10)
  ds_read_b64_tr_b16 v[146:147], v12 offset:2312
  v_mfma_f32_16x16x32_bf16 v[60:63], v[184:187], v[132:135], v[60:63]
  ds_read_b64_tr_b16 v[148:149], v12 offset:16
  v_mfma_f32_16x16x32_bf16 v[96:99], v[184:187], v[136:139], v[96:99]
  ds_read_b64_tr_b16 v[150:151], v12 offset:2320
  v_mfma_f32_16x16x32_bf16 v[64:67], v[188:191], v[132:135], v[64:67]
  ds_read_b64_tr_b16 v[152:153], v12 offset:24
  v_mfma_f32_16x16x32_bf16 v[100:103], v[188:191], v[136:139], v[100:103]
  ds_read_b64_tr_b16 v[154:155], v12 offset:2328
  v_mfma_f32_16x16x32_bf16 v[68:71], v[192:195], v[132:135], v[68:71]
  s_waitcnt lgkmcnt(10)
  ds_read_b64_tr_b16 v[156:157], v12 offset:32
  v_mfma_f32_16x16x32_bf16 v[104:107], v[192:195], v[136:139], v[104:107]
  ds_read_b64_tr_b16 v[158:159], v12 offset:2336
  v_mfma_f32_16x16x32_bf16 v[72:75], v[196:199], v[132:135], v[72:75]
  ds_read_b64_tr_b16 v[160:161], v12 offset:40
  v_mfma_f32_16x16x32_bf16 v[108:111], v[196:199], v[136:139], v[108:111]
  ds_read_b64_tr_b16 v[162:163], v12 offset:2344
  v_mfma_f32_16x16x32_bf16 v[76:79], v[200:203], v[132:135], v[76:79]
  ds_read_b64_tr_b16 v[164:165], v12 offset:48
  v_mfma_f32_16x16x32_bf16 v[112:115], v[200:203], v[136:139], v[112:115]
  s_waitcnt lgkmcnt(10)
  ds_read_b64_tr_b16 v[166:167], v12 offset:2352
  v_mfma_f32_16x16x32_bf16 v[80:83], v[204:207], v[132:135], v[80:83]
  ds_read_b64_tr_b16 v[168:169], v12 offset:56
  v_mfma_f32_16x16x32_bf16 v[116:119], v[204:207], v[136:139], v[116:119]
  ds_read_b64_tr_b16 v[170:171], v12 offset:2360
  v_mfma_f32_16x16x32_bf16 v[84:87], v[208:211], v[132:135], v[84:87]
  ds_read_b64_tr_b16 v[172:173], v12 offset:64
  v_mfma_f32_16x16x32_bf16 v[120:123], v[208:211], v[136:139], v[120:123]
  ds_read_b64_tr_b16 v[174:175], v12 offset:2368
  v_mfma_f32_16x16x32_bf16 v[52:55], v[140:143], v[124:127], v[52:55]
  s_waitcnt lgkmcnt(10)
  ds_read_b128 v[132:135], v11 offset:0
  ds_read_b128 v[136:139], v11 offset:2048
  v_mfma_f32_16x16x32_bf16 v[88:91], v[140:143], v[128:131], v[88:91]
  ds_read_b64_tr_b16 v[176:177], v12 offset:9216
  ds_read_b64_tr_b16 v[178:179], v12 offset:11520
  v_mfma_f32_16x16x32_bf16 v[56:59], v[144:147], v[124:127], v[56:59]
  ds_read_b64_tr_b16 v[180:181], v12 offset:9224
  v_mfma_f32_16x16x32_bf16 v[92:95], v[144:147], v[128:131], v[92:95]
  s_waitcnt lgkmcnt(10)
  ds_read_b64_tr_b16 v[182:183], v12 offset:11528
  v_mfma_f32_16x16x32_bf16 v[60:63], v[148:151], v[124:127], v[60:63]
  ds_read_b64_tr_b16 v[184:185], v12 offset:9232
  ds_read_b64_tr_b16 v[16:17], v13 offset:0
  v_mfma_f32_16x16x32_bf16 v[96:99], v[148:151], v[128:131], v[96:99]
  ds_read_b64_tr_b16 v[186:187], v12 offset:11536
  v_mfma_f32_16x16x32_bf16 v[64:67], v[152:155], v[124:127], v[64:67]
  ds_read_b64_tr_b16 v[188:189], v12 offset:9240
  v_mfma_f32_16x16x32_bf16 v[100:103], v[152:155], v[128:131], v[100:103]
  s_waitcnt lgkmcnt(10)
  ds_read_b64_tr_b16 v[190:191], v12 offset:11544
  v_mfma_f32_16x16x32_bf16 v[68:71], v[156:159], v[124:127], v[68:71]
  ds_read_b64_tr_b16 v[192:193], v12 offset:9248
  ds_read_b64_tr_b16 v[18:19], v13 offset:160
  v_mfma_f32_16x16x32_bf16 v[104:107], v[156:159], v[128:131], v[104:107]
  ds_read_b64_tr_b16 v[194:195], v12 offset:11552
  v_mfma_f32_16x16x32_bf16 v[72:75], v[160:163], v[124:127], v[72:75]
  ds_read_b64_tr_b16 v[196:197], v12 offset:9256
  v_mfma_f32_16x16x32_bf16 v[108:111], v[160:163], v[128:131], v[108:111]
  s_waitcnt lgkmcnt(10)
  ds_read_b64_tr_b16 v[198:199], v12 offset:11560
  v_mfma_f32_16x16x32_bf16 v[76:79], v[164:167], v[124:127], v[76:79]
  ds_read_b64_tr_b16 v[200:201], v12 offset:9264
  v_mfma_f32_16x16x32_bf16 v[112:115], v[164:167], v[128:131], v[112:115]
  ds_read_b64_tr_b16 v[202:203], v12 offset:11568
  v_mfma_f32_16x16x32_bf16 v[80:83], v[168:171], v[124:127], v[80:83]
  ds_read_b64_tr_b16 v[204:205], v12 offset:9272
  v_mfma_f32_16x16x32_bf16 v[116:119], v[168:171], v[128:131], v[116:119]
  ds_read_b64_tr_b16 v[206:207], v12 offset:11576
  v_mfma_f32_16x16x32_bf16 v[84:87], v[172:175], v[124:127], v[84:87]
  s_waitcnt lgkmcnt(10)
  ds_read_b64_tr_b16 v[208:209], v12 offset:9280
  v_mfma_f32_16x16x32_bf16 v[120:123], v[172:175], v[128:131], v[120:123]
  ds_read_b64_tr_b16 v[210:211], v12 offset:11584
  s_waitcnt lgkmcnt(9)
  v_mfma_f32_16x16x32_bf16 v[52:55], v[176:179], v[132:135], v[52:55]
  v_mfma_f32_16x16x32_bf16 v[88:91], v[176:179], v[136:139], v[88:91]
  s_barrier
  v_add_u32 v10, 73728, v7
  v_add_u32 v12, 73728, v9
  v_add_u32 v11, 73728, v8
  ds_read_b128 v[124:127], v10 offset:0
  ds_read_b128 v[128:131], v10 offset:2048
  v_mfma_f32_16x16x32_bf16 v[56:59], v[180:183], v[132:135], v[56:59]
  ds_read_b64_tr_b16 v[140:141], v12 offset:0
  ds_read_b64_tr_b16 v[142:143], v12 offset:2304
  v_mfma_f32_16x16x32_bf16 v[92:95], v[180:183], v[136:139], v[92:95]
  ds_read_b64_tr_b16 v[144:145], v12 offset:8
  ds_read_b64_tr_b16 v[146:147], v12 offset:2312
  v_mfma_f32_16x16x32_bf16 v[60:63], v[184:187], v[132:135], v[60:63]
  s_waitcnt lgkmcnt(10)
  ds_read_b64_tr_b16 v[148:149], v12 offset:16
  ds_read_b64_tr_b16 v[20:21], v13 offset:320
  v_mfma_f32_16x16x32_bf16 v[96:99], v[184:187], v[136:139], v[96:99]
  ds_read_b64_tr_b16 v[150:151], v12 offset:2320
  v_mfma_f32_16x16x32_bf16 v[64:67], v[188:191], v[132:135], v[64:67]
  ds_read_b64_tr_b16 v[152:153], v12 offset:24
  v_mfma_f32_16x16x32_bf16 v[100:103], v[188:191], v[136:139], v[100:103]
  ds_read_b64_tr_b16 v[154:155], v12 offset:2328
  v_mfma_f32_16x16x32_bf16 v[68:71], v[192:195], v[132:135], v[68:71]
  s_waitcnt lgkmcnt(10)
  ds_read_b64_tr_b16 v[156:157], v12 offset:32
  ds_read_b64_tr_b16 v[22:23], v13 offset:480
  v_mfma_f32_16x16x32_bf16 v[104:107], v[192:195], v[136:139], v[104:107]
  ds_read_b64_tr_b16 v[158:159], v12 offset:2336
  v_mfma_f32_16x16x32_bf16 v[72:75], v[196:199], v[132:135], v[72:75]
  ds_read_b64_tr_b16 v[160:161], v12 offset:40
  v_mfma_f32_16x16x32_bf16 v[108:111], v[196:199], v[136:139], v[108:111]
  ds_read_b64_tr_b16 v[162:163], v12 offset:2344
  v_mfma_f32_16x16x32_bf16 v[76:79], v[200:203], v[132:135], v[76:79]
  s_waitcnt lgkmcnt(10)
  ds_read_b64_tr_b16 v[164:165], v12 offset:48
  v_mfma_f32_16x16x32_bf16 v[112:115], v[200:203], v[136:139], v[112:115]
  ds_read_b64_tr_b16 v[166:167], v12 offset:2352
  v_mfma_f32_16x16x32_bf16 v[80:83], v[204:207], v[132:135], v[80:83]
  ds_read_b64_tr_b16 v[168:169], v12 offset:56
  v_mfma_f32_16x16x32_bf16 v[116:119], v[204:207], v[136:139], v[116:119]
  ds_read_b64_tr_b16 v[170:171], v12 offset:2360
  v_mfma_f32_16x16x32_bf16 v[84:87], v[208:211], v[132:135], v[84:87]
  ds_read_b64_tr_b16 v[172:173], v12 offset:64
  v_mfma_f32_16x16x32_bf16 v[120:123], v[208:211], v[136:139], v[120:123]
  s_waitcnt lgkmcnt(10)
  ds_read_b64_tr_b16 v[174:175], v12 offset:2368
  s_waitcnt lgkmcnt(9)
  v_mfma_f32_16x16x32_bf16 v[52:55], v[140:143], v[124:127], v[52:55]
  ds_read_b128 v[132:135], v11 offset:0
  ds_read_b128 v[136:139], v11 offset:2048
  v_mfma_f32_16x16x32_bf16 v[88:91], v[140:143], v[128:131], v[88:91]
  ds_read_b64_tr_b16 v[176:177], v12 offset:9216
  ds_read_b64_tr_b16 v[178:179], v12 offset:11520
  v_mfma_f32_16x16x32_bf16 v[56:59], v[144:147], v[124:127], v[56:59]
  ds_read_b64_tr_b16 v[180:181], v12 offset:9224
  v_mfma_f32_16x16x32_bf16 v[92:95], v[144:147], v[128:131], v[92:95]
  ds_read_b64_tr_b16 v[182:183], v12 offset:11528
  v_mfma_f32_16x16x32_bf16 v[60:63], v[148:151], v[124:127], v[60:63]
  s_waitcnt lgkmcnt(10)
  ds_read_b64_tr_b16 v[184:185], v12 offset:9232
  ds_read_b64_tr_b16 v[24:25], v13 offset:640
  v_mfma_f32_16x16x32_bf16 v[96:99], v[148:151], v[128:131], v[96:99]
  ds_read_b64_tr_b16 v[186:187], v12 offset:11536
  v_mfma_f32_16x16x32_bf16 v[64:67], v[152:155], v[124:127], v[64:67]
  ds_read_b64_tr_b16 v[188:189], v12 offset:9240
  v_mfma_f32_16x16x32_bf16 v[100:103], v[152:155], v[128:131], v[100:103]
  ds_read_b64_tr_b16 v[190:191], v12 offset:11544
  v_mfma_f32_16x16x32_bf16 v[68:71], v[156:159], v[124:127], v[68:71]
  s_waitcnt lgkmcnt(10)
  ds_read_b64_tr_b16 v[192:193], v12 offset:9248
  ds_read_b64_tr_b16 v[26:27], v13 offset:800
  v_mfma_f32_16x16x32_bf16 v[104:107], v[156:159], v[128:131], v[104:107]
  ds_read_b64_tr_b16 v[194:195], v12 offset:11552
  v_mfma_f32_16x16x32_bf16 v[72:75], v[160:163], v[124:127], v[72:75]
  ds_read_b64_tr_b16 v[196:197], v12 offset:9256
  v_mfma_f32_16x16x32_bf16 v[108:111], v[160:163], v[128:131], v[108:111]
  ds_read_b64_tr_b16 v[198:199], v12 offset:11560
  v_mfma_f32_16x16x32_bf16 v[76:79], v[164:167], v[124:127], v[76:79]
  s_waitcnt lgkmcnt(10)
  ds_read_b64_tr_b16 v[200:201], v12 offset:9264
  v_mfma_f32_16x16x32_bf16 v[112:115], v[164:167], v[128:131], v[112:115]
  ds_read_b64_tr_b16 v[202:203], v12 offset:11568
  v_mfma_f32_16x16x32_bf16 v[80:83], v[168:171], v[124:127], v[80:83]
  ds_read_b64_tr_b16 v[204:205], v12 offset:9272
  v_mfma_f32_16x16x32_bf16 v[116:119], v[168:171], v[128:131], v[116:119]
  ds_read_b64_tr_b16 v[206:207], v12 offset:11576
  v_mfma_f32_16x16x32_bf16 v[84:87], v[172:175], v[124:127], v[84:87]
  ds_read_b64_tr_b16 v[208:209], v12 offset:9280
  v_mfma_f32_16x16x32_bf16 v[120:123], v[172:175], v[128:131], v[120:123]
  s_waitcnt lgkmcnt(10)
  ds_read_b64_tr_b16 v[210:211], v12 offset:11584
  s_waitcnt lgkmcnt(9)
  v_mfma_f32_16x16x32_bf16 v[52:55], v[176:179], v[132:135], v[52:55]
  v_mfma_f32_16x16x32_bf16 v[88:91], v[176:179], v[136:139], v[88:91]
  s_barrier
  v_add_u32 v10, 110592, v7
  v_add_u32 v12, 110592, v9
  v_add_u32 v11, 110592, v8
  ds_read_b128 v[124:127], v10 offset:0
  ds_read_b128 v[128:131], v10 offset:2048
  v_mfma_f32_16x16x32_bf16 v[56:59], v[180:183], v[132:135], v[56:59]
  ds_read_b64_tr_b16 v[140:141], v12 offset:0
  ds_read_b64_tr_b16 v[142:143], v12 offset:2304
  v_mfma_f32_16x16x32_bf16 v[92:95], v[180:183], v[136:139], v[92:95]
  ds_read_b64_tr_b16 v[144:145], v12 offset:8
  ds_read_b64_tr_b16 v[146:147], v12 offset:2312
  v_mfma_f32_16x16x32_bf16 v[60:63], v[184:187], v[132:135], v[60:63]
  s_waitcnt lgkmcnt(10)
  ds_read_b64_tr_b16 v[148:149], v12 offset:16
  ds_read_b64_tr_b16 v[28:29], v14 offset:32
  v_mfma_f32_16x16x32_bf16 v[96:99], v[184:187], v[136:139], v[96:99]
  ds_read_b64_tr_b16 v[150:151], v12 offset:2320
  v_mfma_f32_16x16x32_bf16 v[64:67], v[188:191], v[132:135], v[64:67]
  ds_read_b64_tr_b16 v[152:153], v12 offset:24
  v_mfma_f32_16x16x32_bf16 v[100:103], v[188:191], v[136:139], v[100:103]
  ds_read_b64_tr_b16 v[154:155], v12 offset:2328
  v_mfma_f32_16x16x32_bf16 v[68:71], v[192:195], v[132:135], v[68:71]
  s_waitcnt lgkmcnt(10)
  ds_read_b64_tr_b16 v[156:157], v12 offset:32
  ds_read_b64_tr_b16 v[30:31], v14 offset:192
  v_mfma_f32_16x16x32_bf16 v[104:107], v[192:195], v[136:139], v[104:107]
  ds_read_b64_tr_b16 v[158:159], v12 offset:2336
  v_mfma_f32_16x16x32_bf16 v[72:75], v[196:199], v[132:135], v[72:75]
  ds_read_b64_tr_b16 v[160:161], v12 offset:40
  v_mfma_f32_16x16x32_bf16 v[108:111], v[196:199], v[136:139], v[108:111]
  ds_read_b64_tr_b16 v[162:163], v12 offset:2344
  v_mfma_f32_16x16x32_bf16 v[76:79], v[200:203], v[132:135], v[76:79]
  s_waitcnt lgkmcnt(10)
  ds_read_b64_tr_b16 v[164:165], v12 offset:48
  v_mfma_f32_16x16x32_bf16 v[112:115], v[200:203], v[136:139], v[112:115]
  ds_read_b64_tr_b16 v[166:167], v12 offset:2352
  v_mfma_f32_16x16x32_bf16 v[80:83], v[204:207], v[132:135], v[80:83]
  ds_read_b64_tr_b16 v[168:169], v12 offset:56
  v_mfma_f32_16x16x32_bf16 v[116:119], v[204:207], v[136:139], v[116:119]
  ds_read_b64_tr_b16 v[170:171], v12 offset:2360
  v_mfma_f32_16x16x32_bf16 v[84:87], v[208:211], v[132:135], v[84:87]
  ds_read_b64_tr_b16 v[172:173], v12 offset:64
  v_mfma_f32_16x16x32_bf16 v[120:123], v[208:211], v[136:139], v[120:123]
  s_waitcnt lgkmcnt(10)
  ds_read_b64_tr_b16 v[174:175], v12 offset:2368
  s_waitcnt lgkmcnt(9)
  v_mfma_f32_16x16x32_bf16 v[52:55], v[140:143], v[124:127], v[52:55]
  ds_read_b128 v[132:135], v11 offset:0
  ds_read_b128 v[136:139], v11 offset:2048
  v_mfma_f32_16x16x32_bf16 v[88:91], v[140:143], v[128:131], v[88:91]
  ds_read_b64_tr_b16 v[176:177], v12 offset:9216
  ds_read_b64_tr_b16 v[178:179], v12 offset:11520
  v_mfma_f32_16x16x32_bf16 v[56:59], v[144:147], v[124:127], v[56:59]
  ds_read_b64_tr_b16 v[180:181], v12 offset:9224
  v_mfma_f32_16x16x32_bf16 v[92:95], v[144:147], v[128:131], v[92:95]
  ds_read_b64_tr_b16 v[182:183], v12 offset:11528
  v_mfma_f32_16x16x32_bf16 v[60:63], v[148:151], v[124:127], v[60:63]
  s_waitcnt lgkmcnt(10)
  ds_read_b64_tr_b16 v[184:185], v12 offset:9232
  ds_read_b64_tr_b16 v[32:33], v14 offset:352
  v_mfma_f32_16x16x32_bf16 v[96:99], v[148:151], v[128:131], v[96:99]
  ds_read_b64_tr_b16 v[186:187], v12 offset:11536
  v_mfma_f32_16x16x32_bf16 v[64:67], v[152:155], v[124:127], v[64:67]
  ds_read_b64_tr_b16 v[188:189], v12 offset:9240
  v_mfma_f32_16x16x32_bf16 v[100:103], v[152:155], v[128:131], v[100:103]
  ds_read_b64_tr_b16 v[190:191], v12 offset:11544
  v_mfma_f32_16x16x32_bf16 v[68:71], v[156:159], v[124:127], v[68:71]
  s_waitcnt lgkmcnt(10)
  ds_read_b64_tr_b16 v[192:193], v12 offset:9248
  ds_read_b64_tr_b16 v[34:35], v14 offset:512
  v_mfma_f32_16x16x32_bf16 v[104:107], v[156:159], v[128:131], v[104:107]
  ds_read_b64_tr_b16 v[194:195], v12 offset:11552
  v_mfma_f32_16x16x32_bf16 v[72:75], v[160:163], v[124:127], v[72:75]
  ds_read_b64_tr_b16 v[196:197], v12 offset:9256
  v_mfma_f32_16x16x32_bf16 v[108:111], v[160:163], v[128:131], v[108:111]
  ds_read_b64_tr_b16 v[198:199], v12 offset:11560
  v_mfma_f32_16x16x32_bf16 v[76:79], v[164:167], v[124:127], v[76:79]
  s_waitcnt lgkmcnt(10)
  ds_read_b64_tr_b16 v[200:201], v12 offset:9264
  v_mfma_f32_16x16x32_bf16 v[112:115], v[164:167], v[128:131], v[112:115]
  ds_read_b64_tr_b16 v[202:203], v12 offset:11568
  v_mfma_f32_16x16x32_bf16 v[80:83], v[168:171], v[124:127], v[80:83]
  ds_read_b64_tr_b16 v[204:205], v12 offset:9272
  v_mfma_f32_16x16x32_bf16 v[116:119], v[168:171], v[128:131], v[116:119]
  ds_read_b64_tr_b16 v[206:207], v12 offset:11576
  v_mfma_f32_16x16x32_bf16 v[84:87], v[172:175], v[124:127], v[84:87]
  ds_read_b64_tr_b16 v[208:209], v12 offset:9280
  v_mfma_f32_16x16x32_bf16 v[120:123], v[172:175], v[128:131], v[120:123]
  s_waitcnt lgkmcnt(10)
  ds_read_b64_tr_b16 v[210:211], v12 offset:11584
  s_waitcnt lgkmcnt(9)
  v_mfma_f32_16x16x32_bf16 v[52:55], v[176:179], v[132:135], v[52:55]
  v_mfma_f32_16x16x32_bf16 v[88:91], v[176:179], v[136:139], v[88:91]
  s_barrier
  v_add_u32 v10, 0, v7
  v_add_u32 v12, 0, v9
  v_add_u32 v11, 0, v8
  ds_read_b128 v[124:127], v10 offset:0
  ds_read_b128 v[128:131], v10 offset:2048
  v_mfma_f32_16x16x32_bf16 v[56:59], v[180:183], v[132:135], v[56:59]
  ds_read_b64_tr_b16 v[140:141], v12 offset:0
  ds_read_b64_tr_b16 v[142:143], v12 offset:2304
  v_mfma_f32_16x16x32_bf16 v[92:95], v[180:183], v[136:139], v[92:95]
  ds_read_b64_tr_b16 v[144:145], v12 offset:8
  ds_read_b64_tr_b16 v[146:147], v12 offset:2312
  v_mfma_f32_16x16x32_bf16 v[60:63], v[184:187], v[132:135], v[60:63]
  s_waitcnt lgkmcnt(10)
  ds_read_b64_tr_b16 v[148:149], v12 offset:16
  ds_read_b64_tr_b16 v[36:37], v14 offset:672
  v_mfma_f32_16x16x32_bf16 v[96:99], v[184:187], v[136:139], v[96:99]
  ds_read_b64_tr_b16 v[150:151], v12 offset:2320
  v_mfma_f32_16x16x32_bf16 v[64:67], v[188:191], v[132:135], v[64:67]
  ds_read_b64_tr_b16 v[152:153], v12 offset:24
  v_mfma_f32_16x16x32_bf16 v[100:103], v[188:191], v[136:139], v[100:103]
  ds_read_b64_tr_b16 v[154:155], v12 offset:2328
  v_mfma_f32_16x16x32_bf16 v[68:71], v[192:195], v[132:135], v[68:71]
  s_waitcnt lgkmcnt(10)
  ds_read_b64_tr_b16 v[156:157], v12 offset:32
  ds_read_b64_tr_b16 v[38:39], v14 offset:832
  v_mfma_f32_16x16x32_bf16 v[104:107], v[192:195], v[136:139], v[104:107]
  ds_read_b64_tr_b16 v[158:159], v12 offset:2336
  v_mfma_f32_16x16x32_bf16 v[72:75], v[196:199], v[132:135], v[72:75]
  ds_read_b64_tr_b16 v[160:161], v12 offset:40
  v_mfma_f32_16x16x32_bf16 v[108:111], v[196:199], v[136:139], v[108:111]
  ds_read_b64_tr_b16 v[162:163], v12 offset:2344
  v_mfma_f32_16x16x32_bf16 v[76:79], v[200:203], v[132:135], v[76:79]
  s_waitcnt lgkmcnt(10)
  ds_read_b64_tr_b16 v[164:165], v12 offset:48
  v_mfma_f32_16x16x32_bf16 v[112:115], v[200:203], v[136:139], v[112:115]
  ds_read_b64_tr_b16 v[166:167], v12 offset:2352
  v_mfma_f32_16x16x32_bf16 v[80:83], v[204:207], v[132:135], v[80:83]
  ds_read_b64_tr_b16 v[168:169], v12 offset:56
  v_mfma_f32_16x16x32_bf16 v[116:119], v[204:207], v[136:139], v[116:119]
  ds_read_b64_tr_b16 v[170:171], v12 offset:2360
  v_mfma_f32_16x16x32_bf16 v[84:87], v[208:211], v[132:135], v[84:87]
  ds_read_b64_tr_b16 v[172:173], v12 offset:64
  v_mfma_f32_16x16x32_bf16 v[120:123], v[208:211], v[136:139], v[120:123]
  s_waitcnt lgkmcnt(10)
  ds_read_b64_tr_b16 v[174:175], v12 offset:2368
  s_waitcnt lgkmcnt(9)
  v_mfma_f32_16x16x32_bf16 v[52:55], v[140:143], v[124:127], v[52:55]
  ds_read_b128 v[132:135], v11 offset:0
  ds_read_b128 v[136:139], v11 offset:2048
  v_mfma_f32_16x16x32_bf16 v[88:91], v[140:143], v[128:131], v[88:91]
  ds_read_b64_tr_b16 v[176:177], v12 offset:9216
  ds_read_b64_tr_b16 v[178:179], v12 offset:11520
  v_mfma_f32_16x16x32_bf16 v[56:59], v[144:147], v[124:127], v[56:59]
  ds_read_b64_tr_b16 v[180:181], v12 offset:9224
  v_mfma_f32_16x16x32_bf16 v[92:95], v[144:147], v[128:131], v[92:95]
  ds_read_b64_tr_b16 v[182:183], v12 offset:11528
  v_mfma_f32_16x16x32_bf16 v[60:63], v[148:151], v[124:127], v[60:63]
  s_waitcnt lgkmcnt(10)
  ds_read_b64_tr_b16 v[184:185], v12 offset:9232
  v_mfma_f32_16x16x32_bf16 v[96:99], v[148:151], v[128:131], v[96:99]
  ds_read_b64_tr_b16 v[186:187], v12 offset:11536
  v_mfma_f32_16x16x32_bf16 v[64:67], v[152:155], v[124:127], v[64:67]
  ds_read_b64_tr_b16 v[188:189], v12 offset:9240
  v_mfma_f32_16x16x32_bf16 v[100:103], v[152:155], v[128:131], v[100:103]
  ds_read_b64_tr_b16 v[190:191], v12 offset:11544
  v_mfma_f32_16x16x32_bf16 v[68:71], v[156:159], v[124:127], v[68:71]
  ds_read_b64_tr_b16 v[192:193], v12 offset:9248
  v_mfma_f32_16x16x32_bf16 v[104:107], v[156:159], v[128:131], v[104:107]
  s_waitcnt lgkmcnt(10)
  ds_read_b64_tr_b16 v[194:195], v12 offset:11552
  v_mfma_f32_16x16x32_bf16 v[72:75], v[160:163], v[124:127], v[72:75]
  ds_read_b64_tr_b16 v[196:197], v12 offset:9256
  v_mfma_f32_16x16x32_bf16 v[108:111], v[160:163], v[128:131], v[108:111]
  ds_read_b64_tr_b16 v[198:199], v12 offset:11560
  v_mfma_f32_16x16x32_bf16 v[76:79], v[164:167], v[124:127], v[76:79]
  ds_read_b64_tr_b16 v[200:201], v12 offset:9264
  v_mfma_f32_16x16x32_bf16 v[112:115], v[164:167], v[128:131], v[112:115]
  ds_read_b64_tr_b16 v[202:203], v12 offset:11568
  v_mfma_f32_16x16x32_bf16 v[80:83], v[168:171], v[124:127], v[80:83]
  s_waitcnt lgkmcnt(10)
  ds_read_b64_tr_b16 v[204:205], v12 offset:9272
  v_mfma_f32_16x16x32_bf16 v[116:119], v[168:171], v[128:131], v[116:119]
  ds_read_b64_tr_b16 v[206:207], v12 offset:11576
  v_mfma_f32_16x16x32_bf16 v[84:87], v[172:175], v[124:127], v[84:87]
  ds_read_b64_tr_b16 v[208:209], v12 offset:9280
  v_mfma_f32_16x16x32_bf16 v[120:123], v[172:175], v[128:131], v[120:123]
  ds_read_b64_tr_b16 v[210:211], v12 offset:11584
  v_mfma_f32_16x16x32_bf16 v[52:55], v[176:179], v[132:135], v[52:55]
  v_mfma_f32_16x16x32_bf16 v[88:91], v[176:179], v[136:139], v[88:91]
  s_barrier
  v_add_u32 v10, 36864, v7
  v_add_u32 v12, 36864, v9
  v_add_u32 v11, 36864, v8
  ds_read_b128 v[124:127], v10 offset:0
  s_waitcnt lgkmcnt(10)
  ds_read_b128 v[128:131], v10 offset:2048
  v_mfma_f32_16x16x32_bf16 v[56:59], v[180:183], v[132:135], v[56:59]
  ds_read_b64_tr_b16 v[140:141], v12 offset:0
  ds_read_b64_tr_b16 v[142:143], v12 offset:2304
  v_mfma_f32_16x16x32_bf16 v[92:95], v[180:183], v[136:139], v[92:95]
  ds_read_b64_tr_b16 v[144:145], v12 offset:8
  ds_read_b64_tr_b16 v[146:147], v12 offset:2312
  v_mfma_f32_16x16x32_bf16 v[60:63], v[184:187], v[132:135], v[60:63]
  s_waitcnt lgkmcnt(10)
  ds_read_b64_tr_b16 v[148:149], v12 offset:16
  v_mfma_f32_16x16x32_bf16 v[96:99], v[184:187], v[136:139], v[96:99]
  ds_read_b64_tr_b16 v[150:151], v12 offset:2320
  v_mfma_f32_16x16x32_bf16 v[64:67], v[188:191], v[132:135], v[64:67]
  ds_read_b64_tr_b16 v[152:153], v12 offset:24
  v_mfma_f32_16x16x32_bf16 v[100:103], v[188:191], v[136:139], v[100:103]
  ds_read_b64_tr_b16 v[154:155], v12 offset:2328
  v_mfma_f32_16x16x32_bf16 v[68:71], v[192:195], v[132:135], v[68:71]
  ds_read_b64_tr_b16 v[156:157], v12 offset:32
  v_mfma_f32_16x16x32_bf16 v[104:107], v[192:195], v[136:139], v[104:107]
  s_waitcnt lgkmcnt(10)
  ds_read_b64_tr_b16 v[158:159], v12 offset:2336
  v_mfma_f32_16x16x32_bf16 v[72:75], v[196:199], v[132:135], v[72:75]
  ds_read_b64_tr_b16 v[160:161], v12 offset:40
  v_mfma_f32_16x16x32_bf16 v[108:111], v[196:199], v[136:139], v[108:111]
  ds_read_b64_tr_b16 v[162:163], v12 offset:2344
  v_mfma_f32_16x16x32_bf16 v[76:79], v[200:203], v[132:135], v[76:79]
  ds_read_b64_tr_b16 v[164:165], v12 offset:48
  v_mfma_f32_16x16x32_bf16 v[112:115], v[200:203], v[136:139], v[112:115]
  ds_read_b64_tr_b16 v[166:167], v12 offset:2352
  v_mfma_f32_16x16x32_bf16 v[80:83], v[204:207], v[132:135], v[80:83]
  s_waitcnt lgkmcnt(10)
  ds_read_b64_tr_b16 v[168:169], v12 offset:56
  v_mfma_f32_16x16x32_bf16 v[116:119], v[204:207], v[136:139], v[116:119]
  ds_read_b64_tr_b16 v[170:171], v12 offset:2360
  v_mfma_f32_16x16x32_bf16 v[84:87], v[208:211], v[132:135], v[84:87]
  ds_read_b64_tr_b16 v[172:173], v12 offset:64
  v_mfma_f32_16x16x32_bf16 v[120:123], v[208:211], v[136:139], v[120:123]
  ds_read_b64_tr_b16 v[174:175], v12 offset:2368
  v_mfma_f32_16x16x32_bf16 v[52:55], v[140:143], v[124:127], v[52:55]
  ds_read_b128 v[132:135], v11 offset:0
  s_waitcnt lgkmcnt(10)
  ds_read_b128 v[136:139], v11 offset:2048
  v_mfma_f32_16x16x32_bf16 v[88:91], v[140:143], v[128:131], v[88:91]
  ds_read_b64_tr_b16 v[176:177], v12 offset:9216
  ds_read_b64_tr_b16 v[178:179], v12 offset:11520
  v_mfma_f32_16x16x32_bf16 v[56:59], v[144:147], v[124:127], v[56:59]
  ds_read_b64_tr_b16 v[180:181], v12 offset:9224
  v_mfma_f32_16x16x32_bf16 v[92:95], v[144:147], v[128:131], v[92:95]
  ds_read_b64_tr_b16 v[182:183], v12 offset:11528
  v_mfma_f32_16x16x32_bf16 v[60:63], v[148:151], v[124:127], v[60:63]
  s_waitcnt lgkmcnt(10)
  ds_read_b64_tr_b16 v[184:185], v12 offset:9232
  v_mfma_f32_16x16x32_bf16 v[96:99], v[148:151], v[128:131], v[96:99]
  ds_read_b64_tr_b16 v[186:187], v12 offset:11536
  v_mfma_f32_16x16x32_bf16 v[64:67], v[152:155], v[124:127], v[64:67]
  ds_read_b64_tr_b16 v[188:189], v12 offset:9240
  v_mfma_f32_16x16x32_bf16 v[100:103], v[152:155], v[128:131], v[100:103]
  ds_read_b64_tr_b16 v[190:191], v12 offset:11544
  v_mfma_f32_16x16x32_bf16 v[68:71], v[156:159], v[124:127], v[68:71]
  ds_read_b64_tr_b16 v[192:193], v12 offset:9248
  v_mfma_f32_16x16x32_bf16 v[104:107], v[156:159], v[128:131], v[104:107]
  s_waitcnt lgkmcnt(10)
  ds_read_b64_tr_b16 v[194:195], v12 offset:11552
  v_mfma_f32_16x16x32_bf16 v[72:75], v[160:163], v[124:127], v[72:75]
  ds_read_b64_tr_b16 v[196:197], v12 offset:9256
  v_mfma_f32_16x16x32_bf16 v[108:111], v[160:163], v[128:131], v[108:111]
  ds_read_b64_tr_b16 v[198:199], v12 offset:11560
  v_mfma_f32_16x16x32_bf16 v[76:79], v[164:167], v[124:127], v[76:79]
  ds_read_b64_tr_b16 v[200:201], v12 offset:9264
  v_mfma_f32_16x16x32_bf16 v[112:115], v[164:167], v[128:131], v[112:115]
  ds_read_b64_tr_b16 v[202:203], v12 offset:11568
  v_mfma_f32_16x16x32_bf16 v[80:83], v[168:171], v[124:127], v[80:83]
  s_waitcnt lgkmcnt(10)
  ds_read_b64_tr_b16 v[204:205], v12 offset:9272
  v_mfma_f32_16x16x32_bf16 v[116:119], v[168:171], v[128:131], v[116:119]
  ds_read_b64_tr_b16 v[206:207], v12 offset:11576
  v_mfma_f32_16x16x32_bf16 v[84:87], v[172:175], v[124:127], v[84:87]
  ds_read_b64_tr_b16 v[208:209], v12 offset:9280
  v_mfma_f32_16x16x32_bf16 v[120:123], v[172:175], v[128:131], v[120:123]
  ds_read_b64_tr_b16 v[210:211], v12 offset:11584
  v_mfma_f32_16x16x32_bf16 v[52:55], v[176:179], v[132:135], v[52:55]
  v_mfma_f32_16x16x32_bf16 v[88:91], v[176:179], v[136:139], v[88:91]
  s_barrier
  v_add_u32 v10, 73728, v7
  v_add_u32 v12, 73728, v9
  v_add_u32 v11, 73728, v8
  ds_read_b128 v[124:127], v10 offset:0
  s_waitcnt lgkmcnt(10)
  ds_read_b128 v[128:131], v10 offset:2048
  v_mfma_f32_16x16x32_bf16 v[56:59], v[180:183], v[132:135], v[56:59]
  ds_read_b64_tr_b16 v[140:141], v12 offset:0
  ds_read_b64_tr_b16 v[142:143], v12 offset:2304
  v_mfma_f32_16x16x32_bf16 v[92:95], v[180:183], v[136:139], v[92:95]
  ds_read_b64_tr_b16 v[144:145], v12 offset:8
  ds_read_b64_tr_b16 v[146:147], v12 offset:2312
  v_mfma_f32_16x16x32_bf16 v[60:63], v[184:187], v[132:135], v[60:63]
  s_waitcnt lgkmcnt(10)
  ds_read_b64_tr_b16 v[148:149], v12 offset:16
  v_mfma_f32_16x16x32_bf16 v[96:99], v[184:187], v[136:139], v[96:99]
  ds_read_b64_tr_b16 v[150:151], v12 offset:2320
  v_mfma_f32_16x16x32_bf16 v[64:67], v[188:191], v[132:135], v[64:67]
  ds_read_b64_tr_b16 v[152:153], v12 offset:24
  v_mfma_f32_16x16x32_bf16 v[100:103], v[188:191], v[136:139], v[100:103]
  ds_read_b64_tr_b16 v[154:155], v12 offset:2328
  v_mfma_f32_16x16x32_bf16 v[68:71], v[192:195], v[132:135], v[68:71]
  ds_read_b64_tr_b16 v[156:157], v12 offset:32
  v_mfma_f32_16x16x32_bf16 v[104:107], v[192:195], v[136:139], v[104:107]
  s_waitcnt lgkmcnt(10)
  ds_read_b64_tr_b16 v[158:159], v12 offset:2336
  v_mfma_f32_16x16x32_bf16 v[72:75], v[196:199], v[132:135], v[72:75]
  ds_read_b64_tr_b16 v[160:161], v12 offset:40
  v_mfma_f32_16x16x32_bf16 v[108:111], v[196:199], v[136:139], v[108:111]
  ds_read_b64_tr_b16 v[162:163], v12 offset:2344
  v_mfma_f32_16x16x32_bf16 v[76:79], v[200:203], v[132:135], v[76:79]
  ds_read_b64_tr_b16 v[164:165], v12 offset:48
  v_mfma_f32_16x16x32_bf16 v[112:115], v[200:203], v[136:139], v[112:115]
  ds_read_b64_tr_b16 v[166:167], v12 offset:2352
  v_mfma_f32_16x16x32_bf16 v[80:83], v[204:207], v[132:135], v[80:83]
  s_waitcnt lgkmcnt(10)
  ds_read_b64_tr_b16 v[168:169], v12 offset:56
  v_mfma_f32_16x16x32_bf16 v[116:119], v[204:207], v[136:139], v[116:119]
  ds_read_b64_tr_b16 v[170:171], v12 offset:2360
  v_mfma_f32_16x16x32_bf16 v[84:87], v[208:211], v[132:135], v[84:87]
  ds_read_b64_tr_b16 v[172:173], v12 offset:64
  v_mfma_f32_16x16x32_bf16 v[120:123], v[208:211], v[136:139], v[120:123]
  ds_read_b64_tr_b16 v[174:175], v12 offset:2368
  v_mfma_f32_16x16x32_bf16 v[52:55], v[140:143], v[124:127], v[52:55]
  ds_read_b128 v[132:135], v11 offset:0
  s_waitcnt lgkmcnt(10)
  ds_read_b128 v[136:139], v11 offset:2048
  v_mfma_f32_16x16x32_bf16 v[88:91], v[140:143], v[128:131], v[88:91]
  ds_read_b64_tr_b16 v[176:177], v12 offset:9216
  ds_read_b64_tr_b16 v[178:179], v12 offset:11520
  v_mfma_f32_16x16x32_bf16 v[56:59], v[144:147], v[124:127], v[56:59]
  ds_read_b64_tr_b16 v[180:181], v12 offset:9224
  v_mfma_f32_16x16x32_bf16 v[92:95], v[144:147], v[128:131], v[92:95]
  ds_read_b64_tr_b16 v[182:183], v12 offset:11528
  v_mfma_f32_16x16x32_bf16 v[60:63], v[148:151], v[124:127], v[60:63]
  s_waitcnt lgkmcnt(10)
  ds_read_b64_tr_b16 v[184:185], v12 offset:9232
  v_mfma_f32_16x16x32_bf16 v[96:99], v[148:151], v[128:131], v[96:99]
  ds_read_b64_tr_b16 v[186:187], v12 offset:11536
  v_mfma_f32_16x16x32_bf16 v[64:67], v[152:155], v[124:127], v[64:67]
  ds_read_b64_tr_b16 v[188:189], v12 offset:9240
  v_mfma_f32_16x16x32_bf16 v[100:103], v[152:155], v[128:131], v[100:103]
  ds_read_b64_tr_b16 v[190:191], v12 offset:11544
  v_mfma_f32_16x16x32_bf16 v[68:71], v[156:159], v[124:127], v[68:71]
  ds_read_b64_tr_b16 v[192:193], v12 offset:9248
  v_mfma_f32_16x16x32_bf16 v[104:107], v[156:159], v[128:131], v[104:107]
  s_waitcnt lgkmcnt(10)
  ds_read_b64_tr_b16 v[194:195], v12 offset:11552
  v_mfma_f32_16x16x32_bf16 v[72:75], v[160:163], v[124:127], v[72:75]
  ds_read_b64_tr_b16 v[196:197], v12 offset:9256
  v_mfma_f32_16x16x32_bf16 v[108:111], v[160:163], v[128:131], v[108:111]
  ds_read_b64_tr_b16 v[198:199], v12 offset:11560
  v_mfma_f32_16x16x32_bf16 v[76:79], v[164:167], v[124:127], v[76:79]
  ds_read_b64_tr_b16 v[200:201], v12 offset:9264
  v_mfma_f32_16x16x32_bf16 v[112:115], v[164:167], v[128:131], v[112:115]
  ds_read_b64_tr_b16 v[202:203], v12 offset:11568
  v_mfma_f32_16x16x32_bf16 v[80:83], v[168:171], v[124:127], v[80:83]
  s_waitcnt lgkmcnt(10)
  ds_read_b64_tr_b16 v[204:205], v12 offset:9272
  v_mfma_f32_16x16x32_bf16 v[116:119], v[168:171], v[128:131], v[116:119]
  ds_read_b64_tr_b16 v[206:207], v12 offset:11576
  v_mfma_f32_16x16x32_bf16 v[84:87], v[172:175], v[124:127], v[84:87]
  ds_read_b64_tr_b16 v[208:209], v12 offset:9280
  v_mfma_f32_16x16x32_bf16 v[120:123], v[172:175], v[128:131], v[120:123]
  ds_read_b64_tr_b16 v[210:211], v12 offset:11584
  v_mfma_f32_16x16x32_bf16 v[52:55], v[176:179], v[132:135], v[52:55]
  v_mfma_f32_16x16x32_bf16 v[88:91], v[176:179], v[136:139], v[88:91]
  s_barrier
  v_add_u32 v10, 110592, v7
  v_add_u32 v12, 110592, v9
  v_add_u32 v11, 110592, v8
  ds_read_b128 v[124:127], v10 offset:0
  s_waitcnt lgkmcnt(10)
  ds_read_b128 v[128:131], v10 offset:2048
  v_mfma_f32_16x16x32_bf16 v[56:59], v[180:183], v[132:135], v[56:59]
  ds_read_b64_tr_b16 v[140:141], v12 offset:0
  ds_read_b64_tr_b16 v[142:143], v12 offset:2304
  v_mfma_f32_16x16x32_bf16 v[92:95], v[180:183], v[136:139], v[92:95]
  ds_read_b64_tr_b16 v[144:145], v12 offset:8
  ds_read_b64_tr_b16 v[146:147], v12 offset:2312
  v_mfma_f32_16x16x32_bf16 v[60:63], v[184:187], v[132:135], v[60:63]
  s_waitcnt lgkmcnt(10)
  ds_read_b64_tr_b16 v[148:149], v12 offset:16
  v_mfma_f32_16x16x32_bf16 v[96:99], v[184:187], v[136:139], v[96:99]
  ds_read_b64_tr_b16 v[150:151], v12 offset:2320
  v_mfma_f32_16x16x32_bf16 v[64:67], v[188:191], v[132:135], v[64:67]
  ds_read_b64_tr_b16 v[152:153], v12 offset:24
  v_mfma_f32_16x16x32_bf16 v[100:103], v[188:191], v[136:139], v[100:103]
  ds_read_b64_tr_b16 v[154:155], v12 offset:2328
  v_mfma_f32_16x16x32_bf16 v[68:71], v[192:195], v[132:135], v[68:71]
  ds_read_b64_tr_b16 v[156:157], v12 offset:32
  v_mfma_f32_16x16x32_bf16 v[104:107], v[192:195], v[136:139], v[104:107]
  s_waitcnt lgkmcnt(10)
  ds_read_b64_tr_b16 v[158:159], v12 offset:2336
  v_mfma_f32_16x16x32_bf16 v[72:75], v[196:199], v[132:135], v[72:75]
  ds_read_b64_tr_b16 v[160:161], v12 offset:40
  v_mfma_f32_16x16x32_bf16 v[108:111], v[196:199], v[136:139], v[108:111]
  ds_read_b64_tr_b16 v[162:163], v12 offset:2344
  v_mfma_f32_16x16x32_bf16 v[76:79], v[200:203], v[132:135], v[76:79]
  ds_read_b64_tr_b16 v[164:165], v12 offset:48
  v_mfma_f32_16x16x32_bf16 v[112:115], v[200:203], v[136:139], v[112:115]
  ds_read_b64_tr_b16 v[166:167], v12 offset:2352
  v_mfma_f32_16x16x32_bf16 v[80:83], v[204:207], v[132:135], v[80:83]
  s_waitcnt lgkmcnt(10)
  ds_read_b64_tr_b16 v[168:169], v12 offset:56
  v_mfma_f32_16x16x32_bf16 v[116:119], v[204:207], v[136:139], v[116:119]
  ds_read_b64_tr_b16 v[170:171], v12 offset:2360
  v_mfma_f32_16x16x32_bf16 v[84:87], v[208:211], v[132:135], v[84:87]
  ds_read_b64_tr_b16 v[172:173], v12 offset:64
  v_mfma_f32_16x16x32_bf16 v[120:123], v[208:211], v[136:139], v[120:123]
  ds_read_b64_tr_b16 v[174:175], v12 offset:2368
  v_mfma_f32_16x16x32_bf16 v[52:55], v[140:143], v[124:127], v[52:55]
  ds_read_b128 v[132:135], v11 offset:0
  s_waitcnt lgkmcnt(10)
  ds_read_b128 v[136:139], v11 offset:2048
  v_mfma_f32_16x16x32_bf16 v[88:91], v[140:143], v[128:131], v[88:91]
  ds_read_b64_tr_b16 v[176:177], v12 offset:9216
  ds_read_b64_tr_b16 v[178:179], v12 offset:11520
  v_mfma_f32_16x16x32_bf16 v[56:59], v[144:147], v[124:127], v[56:59]
  ds_read_b64_tr_b16 v[180:181], v12 offset:9224
  v_mfma_f32_16x16x32_bf16 v[92:95], v[144:147], v[128:131], v[92:95]
  ds_read_b64_tr_b16 v[182:183], v12 offset:11528
  v_mfma_f32_16x16x32_bf16 v[60:63], v[148:151], v[124:127], v[60:63]
  s_waitcnt lgkmcnt(10)
  ds_read_b64_tr_b16 v[184:185], v12 offset:9232
  v_mfma_f32_16x16x32_bf16 v[96:99], v[148:151], v[128:131], v[96:99]
  ds_read_b64_tr_b16 v[186:187], v12 offset:11536
  v_mfma_f32_16x16x32_bf16 v[64:67], v[152:155], v[124:127], v[64:67]
  ds_read_b64_tr_b16 v[188:189], v12 offset:9240
  v_mfma_f32_16x16x32_bf16 v[100:103], v[152:155], v[128:131], v[100:103]
  ds_read_b64_tr_b16 v[190:191], v12 offset:11544
  v_mfma_f32_16x16x32_bf16 v[68:71], v[156:159], v[124:127], v[68:71]
  ds_read_b64_tr_b16 v[192:193], v12 offset:9248
  v_mfma_f32_16x16x32_bf16 v[104:107], v[156:159], v[128:131], v[104:107]
  s_waitcnt lgkmcnt(10)
  ds_read_b64_tr_b16 v[194:195], v12 offset:11552
  v_mfma_f32_16x16x32_bf16 v[72:75], v[160:163], v[124:127], v[72:75]
  ds_read_b64_tr_b16 v[196:197], v12 offset:9256
  v_mfma_f32_16x16x32_bf16 v[108:111], v[160:163], v[128:131], v[108:111]
  ds_read_b64_tr_b16 v[198:199], v12 offset:11560
  v_mfma_f32_16x16x32_bf16 v[76:79], v[164:167], v[124:127], v[76:79]
  ds_read_b64_tr_b16 v[200:201], v12 offset:9264
  v_mfma_f32_16x16x32_bf16 v[112:115], v[164:167], v[128:131], v[112:115]
  ds_read_b64_tr_b16 v[202:203], v12 offset:11568
  v_mfma_f32_16x16x32_bf16 v[80:83], v[168:171], v[124:127], v[80:83]
  s_waitcnt lgkmcnt(10)
  ds_read_b64_tr_b16 v[204:205], v12 offset:9272
  v_mfma_f32_16x16x32_bf16 v[116:119], v[168:171], v[128:131], v[116:119]
  ds_read_b64_tr_b16 v[206:207], v12 offset:11576
  v_mfma_f32_16x16x32_bf16 v[84:87], v[172:175], v[124:127], v[84:87]
  ds_read_b64_tr_b16 v[208:209], v12 offset:9280
  v_mfma_f32_16x16x32_bf16 v[120:123], v[172:175], v[128:131], v[120:123]
  ds_read_b64_tr_b16 v[210:211], v12 offset:11584
  v_mfma_f32_16x16x32_bf16 v[52:55], v[176:179], v[132:135], v[52:55]
  v_mfma_f32_16x16x32_bf16 v[88:91], v[176:179], v[136:139], v[88:91]
  v_mfma_f32_16x16x32_bf16 v[56:59], v[180:183], v[132:135], v[56:59]
  v_mfma_f32_16x16x32_bf16 v[92:95], v[180:183], v[136:139], v[92:95]
  s_waitcnt lgkmcnt(12)
  v_mfma_f32_16x16x32_bf16 v[60:63], v[184:187], v[132:135], v[60:63]
  v_mfma_f32_16x16x32_bf16 v[96:99], v[184:187], v[136:139], v[96:99]
  s_waitcnt lgkmcnt(10)
  v_mfma_f32_16x16x32_bf16 v[64:67], v[188:191], v[132:135], v[64:67]
  v_mfma_f32_16x16x32_bf16 v[100:103], v[188:191], v[136:139], v[100:103]
  s_waitcnt lgkmcnt(8)
  v_mfma_f32_16x16x32_bf16 v[68:71], v[192:195], v[132:135], v[68:71]
  v_mfma_f32_16x16x32_bf16 v[104:107], v[192:195], v[136:139], v[104:107]
  s_waitcnt lgkmcnt(6)
  v_mfma_f32_16x16x32_bf16 v[72:75], v[196:199], v[132:135], v[72:75]
  v_mfma_f32_16x16x32_bf16 v[108:111], v[196:199], v[136:139], v[108:111]
  s_waitcnt lgkmcnt(4)
  v_mfma_f32_16x16x32_bf16 v[76:79], v[200:203], v[132:135], v[76:79]
  v_mfma_f32_16x16x32_bf16 v[112:115], v[200:203], v[136:139], v[112:115]
  s_waitcnt lgkmcnt(2)
  v_mfma_f32_16x16x32_bf16 v[80:83], v[204:207], v[132:135], v[80:83]
  v_mfma_f32_16x16x32_bf16 v[116:119], v[204:207], v[136:139], v[116:119]
  s_waitcnt lgkmcnt(0)
  v_mfma_f32_16x16x32_bf16 v[84:87], v[208:211], v[132:135], v[84:87]
  v_mfma_f32_16x16x32_bf16 v[120:123], v[208:211], v[136:139], v[120:123]
  s_lshl_b32 s48, s44, 2
  s_add_u32 s48, s48, 158656
  v_mov_b32 v254, s48
  v_mov_b32 v255, 1
  ds_write_b32 v254, v255
  s_cmp_ge_u32 s3, 16
  s_cbranch_scc1 L_qepi
  v_mov_b32 v133, 0
  v_mov_b32 v134, 0
  v_mov_b32 v135, 0
  v_mov_b32 v157, 0x3f80
  v_mov_b32 v167, 0x3f80
  v_cvt_pk_bf16_f32 v136, v70, v71
  v_cvt_pk_bf16_f32 v158, v106, v107
  v_cvt_pk_bf16_f32 v137, v72, v73
  v_cvt_pk_bf16_f32 v159, v108, v109
  v_permlane16_swap_b32 v136, v158
  v_cvt_pk_bf16_f32 v138, v74, v75
  v_cvt_pk_bf16_f32 v160, v110, v111
  v_permlane16_swap_b32 v137, v159
  v_cvt_pk_bf16_f32 v139, v76, v77
  v_cvt_pk_bf16_f32 v161, v112, v113
  v_permlane16_swap_b32 v138, v160
  v_cvt_pk_bf16_f32 v140, v78, v79
  v_cvt_pk_bf16_f32 v162, v114, v115
  v_permlane16_swap_b32 v139, v161
  v_cvt_pk_bf16_f32 v141, v80, v81
  v_cvt_pk_bf16_f32 v163, v116, v117
  v_permlane16_swap_b32 v140, v162
  v_cvt_pk_bf16_f32 v142, v82, v83
  v_cvt_pk_bf16_f32 v164, v118, v119
  v_permlane16_swap_b32 v141, v163
  v_cvt_pk_bf16_f32 v143, v84, v85
  v_cvt_pk_bf16_f32 v165, v120, v121
  v_permlane16_swap_b32 v142, v164
  v_cvt_pk_bf16_f32 v144, v86, v87
  v_cvt_pk_bf16_f32 v166, v122, v123
  v_permlane16_swap_b32 v143, v165
  v_cvt_pk_bf16_f32 v124, v52, v53
  v_cvt_pk_bf16_f32 v148, v88, v89
  v_permlane16_swap_b32 v144, v166
  ds_write_b128 v40, v[136:139]
  ds_write_b128 v40, v[140:143] offset:1024
  ds_write_b32 v41, v144
  s_lshl_b32 s48, s44, 2
  s_add_u32 s48, s48, 158688
  v_mov_b32 v254, s48
  v_mov_b32 v255, 1
  ds_write_b32 v254, v255
  v_cvt_pk_bf16_f32 v125, v54, v55
  v_cvt_pk_bf16_f32 v149, v90, v91
  v_permlane16_swap_b32 v124, v148
  v_cvt_pk_bf16_f32 v126, v56, v57
  v_cvt_pk_bf16_f32 v150, v92, v93
  v_permlane16_swap_b32 v125, v149
  v_cvt_pk_bf16_f32 v127, v58, v59
  v_cvt_pk_bf16_f32 v151, v94, v95
  v_permlane16_swap_b32 v126, v150
  v_cvt_pk_bf16_f32 v128, v60, v61
  v_cvt_pk_bf16_f32 v152, v96, v97
  v_permlane16_swap_b32 v127, v151
  v_cvt_pk_bf16_f32 v129, v62, v63
  v_cvt_pk_bf16_f32 v153, v98, v99
  v_permlane16_swap_b32 v128, v152
  v_cvt_pk_bf16_f32 v130, v64, v65
  v_cvt_pk_bf16_f32 v154, v100, v101
  v_permlane16_swap_b32 v129, v153
  v_cvt_pk_bf16_f32 v131, v66, v67
  v_cvt_pk_bf16_f32 v155, v102, v103
  v_permlane16_swap_b32 v130, v154
  v_cvt_pk_bf16_f32 v132, v68, v69
  v_cvt_pk_bf16_f32 v156, v104, v105
  v_permlane16_swap_b32 v131, v155
  s_nop 0
  v_permlane16_swap_b32 v132, v156
  v_mfma_f32_32x32x16_bf16 v[52:67], v[16:19], v[124:127], 0
  v_mfma_f32_32x32x16_bf16 v[52:67], v[20:23], v[128:131], v[52:67]
  v_mfma_f32_32x32x16_bf16 v[52:67], v[24:27], v[132:135], v[52:67]
  v_mfma_f32_32x32x16_bf16 v[68:83], v[28:31], v[124:127], 0
  v_mfma_f32_32x32x16_bf16 v[68:83], v[32:35], v[128:131], v[68:83]
  v_mfma_f32_32x32x16_bf16 v[68:83], v[36:39], v[132:135], v[68:83]
  v_mov_b32 v254, 158624
  s_mov_b32 s68, 0
L_lf_10:
  ds_read_b128 v[8:11], v254 offset:32
  s_add_u32 s68, s68, 1
  s_cmp_gt_u32 s68, 1048576
  s_waitcnt lgkmcnt(0)
  v_min3_u32 v8, v8, v9, v10
  v_min_u32 v8, v8, v11
  v_cmp_eq_u32 vcc, 0, v8
  s_cbranch_scc1 L_lfd_11
  s_cbranch_vccnz L_lf_10
L_lfd_11:
  s_nop 8
  v_max3_f32 v84, v52, v53, v54
  v_min3_f32 v86, v52, v53, v54
  v_max3_f32 v84, v84, v55, v56
  v_min3_f32 v86, v86, v55, v56
  v_max3_f32 v84, v84, v57, v58
  v_min3_f32 v86, v86, v57, v58
  v_max3_f32 v84, v84, v59, v60
  v_min3_f32 v86, v86, v59, v60
  v_max3_f32 v84, v84, v61, v62
  v_min3_f32 v86, v86, v61, v62
  v_max3_f32 v84, v84, v63, v64
  v_min3_f32 v86, v86, v63, v64
  v_max3_f32 v84, v84, v65, v66
  v_min3_f32 v86, v86, v65, v66
  v_max3_f32 v84, v84, v67, v68
  v_min3_f32 v86, v86, v67, v68
  v_max_f32 v84, v84, v69
  v_min_f32 v86, v86, v69
  v_mul_f32 v85, s46, v84
  v_mul_f32 v87, s46, v86
  v_mul_f32 v84, s46, v84
  v_mul_f32 v86, s46, v86
  v_pk_fma_f32 v[88:89], v[52:53], s[46:47], v[84:85] neg_lo:[0,0,1] neg_hi:[0,0,1]
  v_pk_fma_f32 v[106:107], v[52:53], s[46:47], v[86:87] neg_lo:[1,0,0] neg_hi:[1,0,0]
  v_pk_fma_f32 v[90:91], v[54:55], s[46:47], v[84:85] neg_lo:[0,0,1] neg_hi:[0,0,1]
  v_pk_fma_f32 v[108:109], v[54:55], s[46:47], v[86:87] neg_lo:[1,0,0] neg_hi:[1,0,0]
  v_pk_fma_f32 v[92:93], v[56:57], s[46:47], v[84:85] neg_lo:[0,0,1] neg_hi:[0,0,1]
  v_pk_fma_f32 v[110:111], v[56:57], s[46:47], v[86:87] neg_lo:[1,0,0] neg_hi:[1,0,0]
  v_pk_fma_f32 v[94:95], v[58:59], s[46:47], v[84:85] neg_lo:[0,0,1] neg_hi:[0,0,1]
  v_pk_fma_f32 v[112:113], v[58:59], s[46:47], v[86:87] neg_lo:[1,0,0] neg_hi:[1,0,0]
  v_pk_fma_f32 v[96:97], v[60:61], s[46:47], v[84:85] neg_lo:[0,0,1] neg_hi:[0,0,1]
  v_pk_fma_f32 v[114:115], v[60:61], s[46:47], v[86:87] neg_lo:[1,0,0] neg_hi:[1,0,0]
  v_pk_fma_f32 v[98:99], v[62:63], s[46:47], v[84:85] neg_lo:[0,0,1] neg_hi:[0,0,1]
  v_pk_fma_f32 v[116:117], v[62:63], s[46:47], v[86:87] neg_lo:[1,0,0] neg_hi:[1,0,0]
  v_pk_fma_f32 v[100:101], v[64:65], s[46:47], v[84:85] neg_lo:[0,0,1] neg_hi:[0,0,1]
  v_pk_fma_f32 v[118:119], v[64:65], s[46:47], v[86:87] neg_lo:[1,0,0] neg_hi:[1,0,0]
  v_pk_fma_f32 v[102:103], v[66:67], s[46:47], v[84:85] neg_lo:[0,0,1] neg_hi:[0,0,1]
  v_pk_fma_f32 v[120:121], v[66:67], s[46:47], v[86:87] neg_lo:[1,0,0] neg_hi:[1,0,0]
  v_pk_fma_f32 v[104:105], v[68:69], s[46:47], v[84:85] neg_lo:[0,0,1] neg_hi:[0,0,1]
  v_pk_fma_f32 v[122:123], v[68:69], s[46:47], v[86:87] neg_lo:[1,0,0] neg_hi:[1,0,0]
  v_exp_f32 v88, v88
  v_exp_f32 v106, v106
  v_exp_f32 v89, v89
  v_exp_f32 v107, v107
  v_exp_f32 v90, v90
  v_exp_f32 v108, v108
  v_exp_f32 v91, v91
  v_exp_f32 v109, v109
  v_exp_f32 v92, v92
  v_exp_f32 v110, v110
  v_exp_f32 v93, v93
  v_exp_f32 v111, v111
  ds_write_b128 v42, v[148:151] offset:144
  v_exp_f32 v94, v94
  v_exp_f32 v112, v112
  v_exp_f32 v95, v95
  v_exp_f32 v113, v113
  v_exp_f32 v96, v96
  v_exp_f32 v114, v114
  v_exp_f32 v97, v97
  v_exp_f32 v115, v115
  ds_write_b128 v42, v[152:155] offset:160
  v_exp_f32 v98, v98
  v_exp_f32 v116, v116
  v_exp_f32 v99, v99
  v_exp_f32 v117, v117
  v_exp_f32 v100, v100
  v_exp_f32 v118, v118
  v_exp_f32 v101, v101
  v_exp_f32 v119, v119
  ds_write_b128 v42, v[156:159] offset:176
  v_exp_f32 v102, v102
  v_exp_f32 v120, v120
  v_exp_f32 v103, v103
  v_exp_f32 v121, v121
  v_exp_f32 v104, v104
  v_exp_f32 v122, v122
  v_exp_f32 v105, v105
  v_exp_f32 v123, v123
  ds_write_b128 v42, v[160:163] offset:192
  v_pk_add_f32 v[186:187], v[88:89], v[90:91]
  v_pk_add_f32 v[188:189], v[106:107], v[108:109]
  v_pk_add_f32 v[186:187], v[186:187], v[92:93]
  v_pk_add_f32 v[188:189], v[188:189], v[110:111]
  v_pk_add_f32 v[186:187], v[186:187], v[94:95]
  v_pk_add_f32 v[188:189], v[188:189], v[112:113]
  v_pk_add_f32 v[186:187], v[186:187], v[96:97]
  v_pk_add_f32 v[188:189], v[188:189], v[114:115]
  ds_write_b128 v42, v[164:167] offset:208
  v_pk_add_f32 v[186:187], v[186:187], v[98:99]
  v_pk_add_f32 v[188:189], v[188:189], v[116:117]
  v_pk_add_f32 v[186:187], v[186:187], v[100:101]
  v_pk_add_f32 v[188:189], v[188:189], v[118:119]
  v_pk_add_f32 v[186:187], v[186:187], v[102:103]
  v_pk_add_f32 v[188:189], v[188:189], v[120:121]
  v_pk_add_f32 v[186:187], v[186:187], v[104:105]
  v_pk_add_f32 v[188:189], v[188:189], v[122:123]
  v_add_f32 v186, v186, v187
  v_add_f32 v188, v188, v189
  v_rcp_f32 v186, v186
  v_rcp_f32 v188, v188
  v_mov_b32 v187, v186
  v_mov_b32 v189, v188
  v_pk_mul_f32 v[88:89], v[88:89], v[186:187]
  v_pk_mul_f32 v[90:91], v[90:91], v[186:187]
  v_pk_mul_f32 v[92:93], v[92:93], v[186:187]
  v_cvt_pk_bf16_f32 v168, v88, v89
  v_pk_mul_f32 v[94:95], v[94:95], v[186:187]
  v_cvt_pk_bf16_f32 v169, v90, v91
  v_pk_mul_f32 v[96:97], v[96:97], v[186:187]
  v_cvt_pk_bf16_f32 v170, v92, v93
  v_pk_mul_f32 v[98:99], v[98:99], v[186:187]
  v_cvt_pk_bf16_f32 v171, v94, v95
  ds_write_b128 v42, v[168:171] offset:0
  v_pk_mul_f32 v[100:101], v[100:101], v[186:187]
  v_cvt_pk_bf16_f32 v172, v96, v97
  v_pk_mul_f32 v[102:103], v[102:103], v[186:187]
  v_cvt_pk_bf16_f32 v173, v98, v99
  v_pk_mul_f32 v[104:105], v[104:105], v[186:187]
  v_cvt_pk_bf16_f32 v174, v100, v101
  v_cvt_pk_bf16_f32 v175, v102, v103
  ds_write_b128 v42, v[172:175] offset:16
  v_cvt_pk_bf16_f32 v176, v104, v105
  v_pk_mul_f32 v[106:107], v[106:107], v[188:189]
  v_pk_mul_f32 v[108:109], v[108:109], v[188:189]
  v_pk_mul_f32 v[110:111], v[110:111], v[188:189]
  v_cvt_pk_bf16_f32 v177, v106, v107
  v_pk_mul_f32 v[112:113], v[112:113], v[188:189]
  v_cvt_pk_bf16_f32 v178, v108, v109
  v_pk_mul_f32 v[114:115], v[114:115], v[188:189]
  v_cvt_pk_bf16_f32 v179, v110, v111
  ds_write_b128 v42, v[176:179] offset:32
  v_pk_mul_f32 v[116:117], v[116:117], v[188:189]
  v_cvt_pk_bf16_f32 v180, v112, v113
  v_pk_mul_f32 v[118:119], v[118:119], v[188:189]
  v_cvt_pk_bf16_f32 v181, v114, v115
  v_pk_mul_f32 v[120:121], v[120:121], v[188:189]
  v_cvt_pk_bf16_f32 v182, v116, v117
  v_pk_mul_f32 v[122:123], v[122:123], v[188:189]
  v_cvt_pk_bf16_f32 v183, v118, v119
  ds_write_b128 v42, v[180:183] offset:48
  v_cvt_pk_bf16_f32 v184, v120, v121
  v_cvt_pk_bf16_f32 v185, v122, v123
  ds_write_b64 v42, v[184:185] offset:64
  s_lshl_b32 s48, s44, 2
  s_add_u32 s48, s48, 158624
  v_mov_b32 v254, s48
  v_mov_b32 v255, 1
  ds_write_b32 v254, v255
  v_mov_b32 v254, 158624
  s_mov_b32 s68, 0
L_lf_12:
  ds_read_b128 v[8:11], v254 offset:0
  ds_read_b128 v[12:15], v254 offset:16
  s_add_u32 s68, s68, 1
  s_cmp_gt_u32 s68, 1048576
  s_waitcnt lgkmcnt(0)
  v_min3_u32 v8, v8, v9, v10
  v_min3_u32 v8, v8, v11, v12
  v_min3_u32 v8, v8, v13, v14
  v_min_u32 v8, v8, v15
  v_cmp_eq_u32 vcc, 0, v8
  s_cbranch_scc1 L_lfd_13
  s_cbranch_vccnz L_lf_12
L_lfd_13:
  ds_read_b64_tr_b16 v[32:33], v44 offset:0
  ds_read_b64_tr_b16 v[34:35], v44 offset:464
  ds_read_b64_tr_b16 v[8:9], v43 offset:0
  ds_read_b64_tr_b16 v[10:11], v43 offset:464
  ds_read_b64_tr_b16 v[36:37], v44 offset:32
  ds_read_b64_tr_b16 v[38:39], v44 offset:496
  ds_read_b64_tr_b16 v[12:13], v43 offset:32
  ds_read_b64_tr_b16 v[14:15], v43 offset:496
  ds_read_b64_tr_b16 v[16:17], v43 offset:64
  ds_read_b64_tr_b16 v[18:19], v43 offset:528
  ds_read_b64_tr_b16 v[76:77], v44 offset:14848
  ds_read_b64_tr_b16 v[78:79], v44 offset:15312
  ds_read_b64_tr_b16 v[20:21], v43 offset:14848
  s_waitcnt lgkmcnt(9)
  v_mfma_f32_16x16x32_bf16 v[100:103], v[8:11], v[32:35], 0
  ds_read_b64_tr_b16 v[22:23], v43 offset:15312
  ds_read_b64_tr_b16 v[80:81], v44 offset:14880
  s_waitcnt lgkmcnt(9)
  v_mfma_f32_16x16x32_bf16 v[104:107], v[8:11], v[36:39], 0
  ds_read_b64_tr_b16 v[82:83], v44 offset:15344
  ds_read_b64_tr_b16 v[24:25], v43 offset:14880
  s_waitcnt lgkmcnt(9)
  v_mfma_f32_16x16x32_bf16 v[108:111], v[12:15], v[32:35], 0
  s_waitcnt lgkmcnt(9)
  v_mfma_f32_16x16x32_bf16 v[112:115], v[12:15], v[36:39], 0
  ds_read_b64_tr_b16 v[26:27], v43 offset:15344
  ds_read_b64_tr_b16 v[28:29], v43 offset:14912
  s_waitcnt lgkmcnt(9)
  v_mfma_f32_16x16x32_bf16 v[116:119], v[16:19], v[32:35], 0
  s_waitcnt lgkmcnt(9)
  v_mfma_f32_16x16x32_bf16 v[120:123], v[16:19], v[36:39], 0
  ds_read_b64_tr_b16 v[30:31], v43 offset:15376
  ds_read_b64_tr_b16 v[84:85], v44 offset:29696
  ds_read_b64_tr_b16 v[86:87], v44 offset:30160
  ds_read_b64_tr_b16 v[52:53], v43 offset:29696
  s_waitcnt lgkmcnt(9)
  v_mfma_f32_16x16x32_bf16 v[100:103], v[20:23], v[76:79], v[100:103]
  ds_read_b64_tr_b16 v[54:55], v43 offset:30160
  ds_read_b64_tr_b16 v[88:89], v44 offset:29728
  s_waitcnt lgkmcnt(9)
  v_mfma_f32_16x16x32_bf16 v[104:107], v[20:23], v[80:83], v[104:107]
  ds_read_b64_tr_b16 v[90:91], v44 offset:30192
  ds_read_b64_tr_b16 v[56:57], v43 offset:29728
  s_waitcnt lgkmcnt(9)
  v_mfma_f32_16x16x32_bf16 v[108:111], v[24:27], v[76:79], v[108:111]
  s_waitcnt lgkmcnt(9)
  v_mfma_f32_16x16x32_bf16 v[112:115], v[24:27], v[80:83], v[112:115]
  ds_read_b64_tr_b16 v[58:59], v43 offset:30192
  ds_read_b64_tr_b16 v[60:61], v43 offset:29760
  s_waitcnt lgkmcnt(9)
  v_mfma_f32_16x16x32_bf16 v[116:119], v[28:31], v[76:79], v[116:119]
  s_waitcnt lgkmcnt(9)
  v_mfma_f32_16x16x32_bf16 v[120:123], v[28:31], v[80:83], v[120:123]
  ds_read_b64_tr_b16 v[62:63], v43 offset:30224
  ds_read_b64_tr_b16 v[92:93], v44 offset:44544
  ds_read_b64_tr_b16 v[94:95], v44 offset:45008
  ds_read_b64_tr_b16 v[64:65], v43 offset:44544
  s_waitcnt lgkmcnt(9)
  v_mfma_f32_16x16x32_bf16 v[100:103], v[52:55], v[84:87], v[100:103]
  ds_read_b64_tr_b16 v[66:67], v43 offset:45008
  ds_read_b64_tr_b16 v[96:97], v44 offset:44576
  s_waitcnt lgkmcnt(9)
  v_mfma_f32_16x16x32_bf16 v[104:107], v[52:55], v[88:91], v[104:107]
  ds_read_b64_tr_b16 v[98:99], v44 offset:45040
  ds_read_b64_tr_b16 v[68:69], v43 offset:44576
  s_waitcnt lgkmcnt(9)
  v_mfma_f32_16x16x32_bf16 v[108:111], v[56:59], v[84:87], v[108:111]
  s_waitcnt lgkmcnt(9)
  v_mfma_f32_16x16x32_bf16 v[112:115], v[56:59], v[88:91], v[112:115]
  ds_read_b64_tr_b16 v[70:71], v43 offset:45040
  ds_read_b64_tr_b16 v[72:73], v43 offset:44608
  s_waitcnt lgkmcnt(9)
  v_mfma_f32_16x16x32_bf16 v[116:119], v[60:63], v[84:87], v[116:119]
  s_waitcnt lgkmcnt(9)
  v_mfma_f32_16x16x32_bf16 v[120:123], v[60:63], v[88:91], v[120:123]
  ds_read_b64_tr_b16 v[74:75], v43 offset:45072
  s_waitcnt lgkmcnt(6)
  v_mfma_f32_16x16x32_bf16 v[100:103], v[64:67], v[92:95], v[100:103]
  s_waitcnt lgkmcnt(4)
  v_mfma_f32_16x16x32_bf16 v[104:107], v[64:67], v[96:99], v[104:107]
  s_waitcnt lgkmcnt(2)
  v_mfma_f32_16x16x32_bf16 v[108:111], v[68:71], v[92:95], v[108:111]
  s_waitcnt lgkmcnt(2)
  v_mfma_f32_16x16x32_bf16 v[112:115], v[68:71], v[96:99], v[112:115]
  s_waitcnt lgkmcnt(0)
  v_mfma_f32_16x16x32_bf16 v[116:119], v[72:75], v[92:95], v[116:119]
  s_waitcnt lgkmcnt(0)
  v_mfma_f32_16x16x32_bf16 v[120:123], v[72:75], v[96:99], v[120:123]
  v_cvt_pk_bf16_f32 v124, v100, v101
  v_cvt_pk_bf16_f32 v125, v102, v103
  v_cvt_pk_bf16_f32 v126, v108, v109
  v_cvt_pk_bf16_f32 v127, v110, v111
  buffer_store_dwordx4 v[124:127], v45, s[32:35], s56 offen offset:0 sc1
  v_cvt_pk_bf16_f32 v128, v104, v105
  v_cvt_pk_bf16_f32 v129, v106, v107
  v_cvt_pk_bf16_f32 v130, v112, v113
  v_cvt_pk_bf16_f32 v131, v114, v115
  buffer_store_dwordx4 v[128:131], v46, s[32:35], s56 offen offset:1024 sc1
  v_cvt_pk_bf16_f32 v132, v116, v117
  v_cvt_pk_bf16_f32 v133, v118, v119
  buffer_store_dwordx2 v[132:133], v47, s[32:35], s56 offen offset:1280 sc1
  v_cvt_pk_bf16_f32 v134, v120, v121
  v_cvt_pk_bf16_f32 v135, v122, v123
  buffer_store_dwordx2 v[134:135], v48, s[32:35], s56 offen offset:1408 sc1
  s_nop 1
  s_branch L_tail
L_qepi:
  v_cvt_pk_bf16_f32 v124, v52, v53
  v_cvt_pk_bf16_f32 v125, v54, v55
  v_cvt_pk_bf16_f32 v126, v56, v57
  v_cvt_pk_bf16_f32 v127, v58, v59
  v_cvt_pk_bf16_f32 v128, v60, v61
  v_cvt_pk_bf16_f32 v129, v62, v63
  v_cvt_pk_bf16_f32 v130, v64, v65
  v_cvt_pk_bf16_f32 v131, v66, v67
  v_cvt_pk_bf16_f32 v132, v68, v69
  buffer_store_dwordx4 v[124:127], v43, s[32:35], s56 offen offset:0 sc1
  buffer_store_dwordx4 v[128:131], v43, s[32:35], s56 offen offset:1024 sc1
  buffer_store_dword v132, v44, s[32:35], s56 offen offset:2048 sc1
  v_cvt_pk_bf16_f32 v144, v88, v89
  v_cvt_pk_bf16_f32 v145, v90, v91
  v_cvt_pk_bf16_f32 v146, v92, v93
  v_cvt_pk_bf16_f32 v147, v94, v95
  v_cvt_pk_bf16_f32 v148, v96, v97
  v_cvt_pk_bf16_f32 v149, v98, v99
  v_cvt_pk_bf16_f32 v150, v100, v101
  v_cvt_pk_bf16_f32 v151, v102, v103
  v_cvt_pk_bf16_f32 v152, v104, v105
  buffer_store_dwordx4 v[144:147], v43, s[32:35], s56 offen offset:256 sc1
  buffer_store_dwordx4 v[148:151], v43, s[32:35], s56 offen offset:1280 sc1
  buffer_store_dword v152, v44, s[32:35], s56 offen offset:2112 sc1
  v_cvt_pk_bf16_f32 v134, v70, v71
  v_cvt_pk_bf16_f32 v135, v72, v73
  v_cvt_pk_bf16_f32 v136, v74, v75
  v_cvt_pk_bf16_f32 v137, v76, v77
  v_cvt_pk_bf16_f32 v138, v78, v79
  v_cvt_pk_bf16_f32 v139, v80, v81
  v_cvt_pk_bf16_f32 v140, v82, v83
  v_cvt_pk_bf16_f32 v141, v84, v85
  v_cvt_pk_bf16_f32 v142, v86, v87
  buffer_store_dwordx4 v[134:137], v43, s[32:35], s56 offen offset:512 sc1
  buffer_store_dwordx4 v[138:141], v43, s[32:35], s56 offen offset:1536 sc1
  buffer_store_dword v142, v44, s[32:35], s56 offen offset:2176 sc1
  v_cvt_pk_bf16_f32 v154, v106, v107
  v_cvt_pk_bf16_f32 v155, v108, v109
  v_cvt_pk_bf16_f32 v156, v110, v111
  v_cvt_pk_bf16_f32 v157, v112, v113
  v_cvt_pk_bf16_f32 v158, v114, v115
  v_cvt_pk_bf16_f32 v159, v116, v117
  v_cvt_pk_bf16_f32 v160, v118, v119
  v_cvt_pk_bf16_f32 v161, v120, v121
  v_cvt_pk_bf16_f32 v162, v122, v123
  buffer_store_dwordx4 v[154:157], v43, s[32:35], s56 offen offset:768 sc1
  buffer_store_dwordx4 v[158:161], v43, s[32:35], s56 offen offset:1792 sc1
  buffer_store_dword v162, v44, s[32:35], s56 offen offset:2240 sc1
  s_lshl_b32 s48, s44, 2
  s_add_u32 s48, s48, 158672
  v_mov_b32 v254, s48
  v_mov_b32 v255, 1
  ds_write_b32 v254, v255
  s_lshl_b32 s48, s62, 2
  s_add_u32 s48, s48, s63
  s_lshl_b32 s48, s48, 2
  s_add_u32 s48, s48, s44
  s_lshl_b32 s48, s48, 7
  s_add_u32 s48, s48, 3145728
  s_waitcnt vmcnt(0)
  s_mov_b64 exec, 1
  v_mov_b32 v255, s72
  v_mov_b32 v254, 0
  buffer_store_dword v255, v254, s[32:35], s48 offen sc1
  s_mov_b64 exec, -1
L_tail:
  v_and_b32 v2, 15, v1
  v_lshrrev_b32 v3, 4, v1
  v_mul_u32_u24 v64, 3072, v3
  v_lshl_add_u32 v64, v2, 4, v64
  s_and_b32 s48, s44, 1
  s_cmp_eq_u32 s48, 1
  s_cselect_b32 s49, 10, 16
  v_mov_b32 v5, 1073741824
  v_cmp_gt_u32 vcc, s49, v2
  s_nop 1
  v_cndmask_b32 v65, v5, v64, vcc
  v_lshrrev_b32 v4, 1, v2
  v_and_b32 v5, 1, v2
  v_lshlrev_b32 v5, 4, v5
  v_mov_b32 v68, 0x3f80
  v_lshlrev_b32 v5, v5, v68
  v_cmp_eq_u32 vcc, 0, v4
  s_nop 1
  v_cndmask_b32 v68, 0, v5, vcc
  v_cmp_eq_u32 vcc, 1, v4
  s_nop 1
  v_cndmask_b32 v69, 0, v5, vcc
  v_cmp_eq_u32 vcc, 2, v4
  s_nop 1
  v_cndmask_b32 v70, 0, v5, vcc
  v_cmp_eq_u32 vcc, 3, v4
  s_nop 1
  v_cndmask_b32 v71, 0, v5, vcc
  s_lshr_b32 s50, s44, 1
  s_mul_i32 s50, s50, 1920
  s_add_u32 s50, s50, 154624
  s_cmp_eq_u32 s48, 1
  s_cselect_b64 s[54:55], -1, 0
  v_mov_b32 v78, v2
  s_mul_i32 s49, s48, 12
  v_lshl_add_u32 v79, v3, 4, s49
  v_mul_u32_u24 v4, 96, v78
  v_lshl_add_u32 v4, v79, 1, v4
  v_add_u32 v4, s50, v4
  v_add_u32 v5, 12, v4
  v_cmp_le_u32 vcc, 18, v79
  s_nop 1
  v_cndmask_b32 v72, v4, v5, vcc
  v_cmp_le_u32 vcc, 16, v79
  s_nop 1
  v_cndmask_b32 v73, v4, v5, vcc
  v_cmp_gt_u32 vcc, 20, v78
  v_cmp_gt_u32 s[52:53], 2, v3
  s_nop 0
  s_and_b64 vcc, vcc, s[52:53]
  v_mov_b32 v4, 158592
  v_cndmask_b32 v72, v4, v72, vcc
  v_cndmask_b32 v73, v4, v73, vcc
  v_and_b32 v4, 3, v2
  v_add_u32 v4, 16, v4
  v_cndmask_b32 v78, v2, v4, s[54:55]
  v_and_b32 v4, 12, v2
  v_cndmask_b32 v4, 4, v4, s[54:55]
  v_lshl_add_u32 v79, v3, 4, v4
  v_mul_u32_u24 v4, 96, v78
  v_lshl_add_u32 v4, v79, 1, v4
  v_add_u32 v4, s50, v4
  v_add_u32 v5, 12, v4
  v_cmp_le_u32 vcc, 18, v79
  s_nop 1
  v_cndmask_b32 v74, v4, v5, vcc
  v_cmp_le_u32 vcc, 16, v79
  s_nop 1
  v_cndmask_b32 v75, v4, v5, vcc
  v_cmp_gt_u32 vcc, 20, v78
  v_cmp_gt_u32 s[52:53], 2, v3
  s_nop 0
  s_and_b64 vcc, vcc, s[52:53]
  v_mov_b32 v4, 158592
  v_cndmask_b32 v74, v4, v74, vcc
  v_cndmask_b32 v75, v4, v75, vcc
  v_lshl_add_u32 v4, v2, 1, v3
  v_cndmask_b32 v78, v2, v4, s[54:55]
  v_lshl_add_u32 v4, v3, 4, 8
  v_cndmask_b32 v79, v4, 32, s[54:55]
  v_mul_u32_u24 v4, 96, v78
  v_lshl_add_u32 v4, v79, 1, v4
  v_add_u32 v4, s50, v4
  v_add_u32 v5, 12, v4
  v_cmp_le_u32 vcc, 18, v79
  s_nop 1
  v_cndmask_b32 v76, v4, v5, vcc
  v_cmp_le_u32 vcc, 16, v79
  s_nop 1
  v_cndmask_b32 v77, v4, v5, vcc
  v_cmp_gt_u32 vcc, 20, v78
  v_cmp_gt_u32 s[52:53], 2, v3
  s_nop 0
  s_and_b64 vcc, vcc, s[52:53]
  v_mov_b32 v4, 158592
  v_cndmask_b32 v76, v4, v76, vcc
  v_cndmask_b32 v77, v4, v77, vcc
  s_mul_i32 s60, s66, 49152
  s_lshr_b32 s49, s44, 1
  s_mul_i32 s49, s49, 1536
  s_add_u32 s60, s60, s49
  s_add_u32 s60, s60, 0
  s_mul_i32 s48, s48, 768
  s_add_u32 s56, s48, s60
  s_add_u32 s57, s56, 12288
  s_add_u32 s58, s56, 24576
  s_add_u32 s59, s56, 36864
  s_lshl_b32 s48, s66, 1
  s_lshr_b32 s50, s44, 1
  s_add_u32 s48, s48, s50
  s_lshl_b32 s48, s48, 11
  s_add_u32 s48, s48, 3186688
  s_add_u32 s49, s60, 1408
  s_mov_b32 s74, 0xffff0000
  s_mov_b32 s75, -1
  v_and_b32 v254, 15, v1
  v_mul_u32_u24 v66, 3072, v254
  v_add_u32 v66, s49, v66
  v_lshl_add_u32 v254, v254, 7, s48
  v_cndmask_b32 v66, v66, v254, s[74:75]
  v_mov_b32 v254, s72
  v_cndmask_b32 v67, -1, v254, s[74:75]
  s_cmp_lt_u32 s3, 16
  s_cbranch_scc1 L_sum
L_phis:
  v_and_b32 v164, 1, v1
  v_lshrrev_b32 v78, 5, v1
  v_cmp_eq_u32 vcc, v164, v78
  v_mul_u32_u24 v79, 960, v164
  v_bfe_u32 v164, v1, 2, 2
  v_mad_u32_u24 v79, v164, 40, v79
  v_add_u32 v79, 152576, v79
  v_mov_b32 v164, 158720
  v_cndmask_b32 v79, v164, v79, vcc
  v_bfe_u32 v164, v1, 4, 1
  v_lshl_add_u32 v78, v164, 4, v79
  v_bfe_u32 v164, v1, 1, 1
  v_lshl_add_u32 v78, v164, 3, v78
  ds_read_b64_tr_b16 v[140:141], v78 offset:0
  ds_read_b64_tr_b16 v[142:143], v78 offset:160
  ds_read_b64_tr_b16 v[144:145], v78 offset:320
  ds_read_b64_tr_b16 v[146:147], v78 offset:480
  ds_read_b64_tr_b16 v[148:149], v78 offset:640
  ds_read_b64_tr_b16 v[150:151], v78 offset:800
  ds_read_b64_tr_b16 v[152:153], v79 offset:32
  ds_read_b64_tr_b16 v[154:155], v79 offset:192
  ds_read_b64_tr_b16 v[156:157], v79 offset:352
  ds_read_b64_tr_b16 v[158:159], v79 offset:512
  ds_read_b64_tr_b16 v[160:161], v79 offset:672
  ds_read_b64_tr_b16 v[162:163], v79 offset:832
  v_bfe_u32 v2, v1, 3, 2
  v_and_b32 v3, 3, v1
  v_lshl_add_u32 v2, v2, 2, v3
  v_bfe_u32 v3, v1, 2, 1
  v_lshl_add_u32 v4, v3, 3, v2
  v_lshl_add_u32 v3, v3, 1, 8
  v_cmp_lt_u32 vcc, v2, v3
  s_nop 1
  v_cndmask_b32 v4, 19, v4, vcc
  v_cmp_ne_u32 vcc, 10, v2
  s_nop 1
  v_cndmask_b32 v4, 18, v4, vcc
  v_mul_u32_u24 v4, 96, v4
  v_lshrrev_b32 v2, 5, v1
  v_mad_u32_u24 v4, v2, 48, v4
  v_add_u32 v7, 154624, v4
  v_bfe_u32 v2, v1, 4, 1
  v_lshlrev_b32 v3, 14, v2
  v_lshlrev_b32 v2, 11, v2
  v_and_b32 v4, 15, v1
  v_lshl_add_u32 v3, v4, 4, v3
  v_lshl_add_u32 v2, v4, 3, v2
  v_lshrrev_b32 v4, 5, v1
  v_lshl_add_u32 v30, v4, 8, v3
  v_mov_b32 v5, 1073741824
  v_cmp_eq_u32 vcc, 1, v4
  s_nop 1
  v_cndmask_b32 v31, v5, v2, vcc
  v_mov_b32 v177, 0
  v_mov_b32 v178, 0
  v_mov_b32 v179, 0
  v_mov_b32 v17, 0
  v_mov_b32 v27, 0
  v_mov_b32 v28, 0
  v_mov_b32 v29, 0
  s_lshl_b32 s48, s67, 2
  s_lshr_b32 s49, s66, 2
  s_add_u32 s48, s48, s49
  s_lshl_b32 s48, s48, 2
  s_add_u32 s48, s48, s44
  s_lshl_b32 s48, s48, 7
  s_add_u32 s53, s48, 3145728
  s_lshl_b32 s48, s67, 4
  s_add_u32 s48, s48, s66
  s_lshl_b32 s48, s48, 2
  s_add_u32 s48, s48, s44
  s_mul_i32 s48, s48, 2304
  s_add_u32 s48, s48, 4194304
  v_mov_b32 v2, 0
  v_lshlrev_b32 v4, 4, v1
  v_lshlrev_b32 v5, 2, v1
  s_mov_b32 s68, 0
L_poll_14:
  buffer_load_dword v3, v2, s[32:35], s53 offen sc1
  s_add_u32 s68, s68, 1
  s_cmp_gt_u32 s68, 65536
  s_cbranch_scc1 L_pdone_15
  s_waitcnt vmcnt(0)
  v_cmp_ne_u32 vcc, s72, v3
  s_cbranch_vccnz L_poll_14
L_pdone_15:
  s_waitcnt vmcnt(0)
  buffer_load_dwordx4 v[168:171], v4, s[32:35], s48 offen sc1
  buffer_load_dwordx4 v[172:175], v4, s[32:35], s48 offen offset:1024 sc1
  buffer_load_dword v176, v5, s[32:35], s48 offen offset:2048 sc1
  s_waitcnt vmcnt(0) lgkmcnt(0)
  v_mfma_f32_32x32x16_bf16 v[32:47], v[140:143], v[168:171], 0
  v_mfma_f32_32x32x16_bf16 v[32:47], v[144:147], v[172:175], v[32:47]
  v_mfma_f32_32x32x16_bf16 v[32:47], v[148:151], v[176:179], v[32:47]
  v_mfma_f32_32x32x16_bf16 v[48:63], v[152:155], v[168:171], 0
  v_mfma_f32_32x32x16_bf16 v[48:63], v[156:159], v[172:175], v[48:63]
  v_mfma_f32_32x32x16_bf16 v[48:63], v[160:163], v[176:179], v[48:63]
  s_nop 8
  v_max3_f32 v180, v32, v33, v34
  v_min3_f32 v182, v32, v33, v34
  v_max3_f32 v180, v180, v35, v36
  v_min3_f32 v182, v182, v35, v36
  v_max3_f32 v180, v180, v37, v38
  v_min3_f32 v182, v182, v37, v38
  v_max3_f32 v180, v180, v39, v40
  v_min3_f32 v182, v182, v39, v40
  v_max3_f32 v180, v180, v41, v42
  v_min3_f32 v182, v182, v41, v42
  v_max3_f32 v180, v180, v43, v44
  v_min3_f32 v182, v182, v43, v44
  v_max3_f32 v180, v180, v45, v46
  v_min3_f32 v182, v182, v45, v46
  v_max3_f32 v180, v180, v47, v48
  v_min3_f32 v182, v182, v47, v48
  v_max_f32 v180, v180, v49
  v_min_f32 v182, v182, v49
  v_mul_f32 v181, s46, v180
  v_mul_f32 v183, s46, v182
  v_mul_f32 v180, s46, v180
  v_mul_f32 v182, s46, v182
  v_pk_fma_f32 v[184:185], v[32:33], s[46:47], v[180:181] neg_lo:[0,0,1] neg_hi:[0,0,1]
  v_pk_fma_f32 v[202:203], v[32:33], s[46:47], v[182:183] neg_lo:[1,0,0] neg_hi:[1,0,0]
  v_pk_fma_f32 v[186:187], v[34:35], s[46:47], v[180:181] neg_lo:[0,0,1] neg_hi:[0,0,1]
  v_pk_fma_f32 v[204:205], v[34:35], s[46:47], v[182:183] neg_lo:[1,0,0] neg_hi:[1,0,0]
  v_pk_fma_f32 v[188:189], v[36:37], s[46:47], v[180:181] neg_lo:[0,0,1] neg_hi:[0,0,1]
  v_pk_fma_f32 v[206:207], v[36:37], s[46:47], v[182:183] neg_lo:[1,0,0] neg_hi:[1,0,0]
  v_pk_fma_f32 v[190:191], v[38:39], s[46:47], v[180:181] neg_lo:[0,0,1] neg_hi:[0,0,1]
  v_pk_fma_f32 v[208:209], v[38:39], s[46:47], v[182:183] neg_lo:[1,0,0] neg_hi:[1,0,0]
  v_pk_fma_f32 v[192:193], v[40:41], s[46:47], v[180:181] neg_lo:[0,0,1] neg_hi:[0,0,1]
  v_pk_fma_f32 v[210:211], v[40:41], s[46:47], v[182:183] neg_lo:[1,0,0] neg_hi:[1,0,0]
  v_pk_fma_f32 v[194:195], v[42:43], s[46:47], v[180:181] neg_lo:[0,0,1] neg_hi:[0,0,1]
  v_pk_fma_f32 v[212:213], v[42:43], s[46:47], v[182:183] neg_lo:[1,0,0] neg_hi:[1,0,0]
  v_pk_fma_f32 v[196:197], v[44:45], s[46:47], v[180:181] neg_lo:[0,0,1] neg_hi:[0,0,1]
  v_pk_fma_f32 v[214:215], v[44:45], s[46:47], v[182:183] neg_lo:[1,0,0] neg_hi:[1,0,0]
  v_pk_fma_f32 v[198:199], v[46:47], s[46:47], v[180:181] neg_lo:[0,0,1] neg_hi:[0,0,1]
  v_pk_fma_f32 v[216:217], v[46:47], s[46:47], v[182:183] neg_lo:[1,0,0] neg_hi:[1,0,0]
  v_pk_fma_f32 v[200:201], v[48:49], s[46:47], v[180:181] neg_lo:[0,0,1] neg_hi:[0,0,1]
  v_pk_fma_f32 v[218:219], v[48:49], s[46:47], v[182:183] neg_lo:[1,0,0] neg_hi:[1,0,0]
  v_exp_f32 v184, v184
  v_exp_f32 v202, v202
  v_exp_f32 v185, v185
  v_exp_f32 v203, v203
  v_exp_f32 v186, v186
  v_exp_f32 v204, v204
  v_exp_f32 v187, v187
  v_exp_f32 v205, v205
  v_exp_f32 v188, v188
  v_exp_f32 v206, v206
  v_exp_f32 v189, v189
  v_exp_f32 v207, v207
  v_exp_f32 v190, v190
  v_exp_f32 v208, v208
  v_exp_f32 v191, v191
  v_exp_f32 v209, v209
  v_exp_f32 v192, v192
  v_exp_f32 v210, v210
  v_exp_f32 v193, v193
  v_exp_f32 v211, v211
  v_exp_f32 v194, v194
  v_exp_f32 v212, v212
  v_exp_f32 v195, v195
  v_exp_f32 v213, v213
  v_exp_f32 v196, v196
  v_exp_f32 v214, v214
  v_exp_f32 v197, v197
  v_exp_f32 v215, v215
  v_exp_f32 v198, v198
  v_exp_f32 v216, v216
  v_exp_f32 v199, v199
  v_exp_f32 v217, v217
  v_exp_f32 v200, v200
  v_exp_f32 v218, v218
  v_exp_f32 v201, v201
  v_exp_f32 v219, v219
  v_pk_add_f32 v[220:221], v[184:185], v[186:187]
  v_pk_add_f32 v[222:223], v[202:203], v[204:205]
  v_pk_add_f32 v[220:221], v[220:221], v[188:189]
  v_pk_add_f32 v[222:223], v[222:223], v[206:207]
  v_pk_add_f32 v[220:221], v[220:221], v[190:191]
  v_pk_add_f32 v[222:223], v[222:223], v[208:209]
  v_pk_add_f32 v[220:221], v[220:221], v[192:193]
  v_pk_add_f32 v[222:223], v[222:223], v[210:211]
  v_pk_add_f32 v[220:221], v[220:221], v[194:195]
  v_pk_add_f32 v[222:223], v[222:223], v[212:213]
  v_pk_add_f32 v[220:221], v[220:221], v[196:197]
  v_pk_add_f32 v[222:223], v[222:223], v[214:215]
  v_pk_add_f32 v[220:221], v[220:221], v[198:199]
  v_pk_add_f32 v[222:223], v[222:223], v[216:217]
  v_pk_add_f32 v[220:221], v[220:221], v[200:201]
  v_pk_add_f32 v[222:223], v[222:223], v[218:219]
  v_add_f32 v220, v220, v221
  v_add_f32 v222, v222, v223
  v_rcp_f32 v220, v220
  v_rcp_f32 v222, v222
  v_mov_b32 v221, v220
  v_mov_b32 v223, v222
  v_pk_mul_f32 v[184:185], v[184:185], v[220:221]
  v_pk_mul_f32 v[186:187], v[186:187], v[220:221]
  v_pk_mul_f32 v[188:189], v[188:189], v[220:221]
  v_cvt_pk_bf16_f32 v8, v184, v185
  v_pk_mul_f32 v[190:191], v[190:191], v[220:221]
  v_cvt_pk_bf16_f32 v9, v186, v187
  v_pk_mul_f32 v[192:193], v[192:193], v[220:221]
  v_cvt_pk_bf16_f32 v10, v188, v189
  v_pk_mul_f32 v[194:195], v[194:195], v[220:221]
  v_cvt_pk_bf16_f32 v11, v190, v191
  v_pk_mul_f32 v[196:197], v[196:197], v[220:221]
  v_cvt_pk_bf16_f32 v12, v192, v193
  v_pk_mul_f32 v[198:199], v[198:199], v[220:221]
  v_cvt_pk_bf16_f32 v13, v194, v195
  v_pk_mul_f32 v[200:201], v[200:201], v[220:221]
  v_cvt_pk_bf16_f32 v14, v196, v197
  v_cvt_pk_bf16_f32 v15, v198, v199
  v_cvt_pk_bf16_f32 v16, v200, v201
  v_pk_mul_f32 v[202:203], v[202:203], v[222:223]
  v_pk_mul_f32 v[204:205], v[204:205], v[222:223]
  v_pk_mul_f32 v[206:207], v[206:207], v[222:223]
  v_cvt_pk_bf16_f32 v18, v202, v203
  v_pk_mul_f32 v[208:209], v[208:209], v[222:223]
  v_cvt_pk_bf16_f32 v19, v204, v205
  v_pk_mul_f32 v[210:211], v[210:211], v[222:223]
  v_cvt_pk_bf16_f32 v20, v206, v207
  v_pk_mul_f32 v[212:213], v[212:213], v[222:223]
  v_cvt_pk_bf16_f32 v21, v208, v209
  v_pk_mul_f32 v[214:215], v[214:215], v[222:223]
  v_cvt_pk_bf16_f32 v22, v210, v211
  v_pk_mul_f32 v[216:217], v[216:217], v[222:223]
  v_cvt_pk_bf16_f32 v23, v212, v213
  v_pk_mul_f32 v[218:219], v[218:219], v[222:223]
  v_cvt_pk_bf16_f32 v24, v214, v215
  v_cvt_pk_bf16_f32 v25, v216, v217
  v_cvt_pk_bf16_f32 v26, v218, v219
  v_permlane32_swap_b32 v8, v18
  v_permlane32_swap_b32 v9, v19
  v_permlane32_swap_b32 v10, v20
  v_permlane32_swap_b32 v11, v21
  v_permlane32_swap_b32 v12, v22
  v_permlane32_swap_b32 v13, v23
  v_permlane32_swap_b32 v14, v24
  v_permlane32_swap_b32 v15, v25
  v_permlane32_swap_b32 v16, v26
  s_waitcnt vmcnt(0)
  s_cmp_eq_u32 s71, 0
  s_cbranch_scc0 L_e4
L_sum:
  s_mov_b32 s68, 0
L_poll_16:
  buffer_load_dword v3, v66, s[32:35], 0 offen sc1
  s_add_u32 s68, s68, 1
  s_cmp_gt_u32 s68, 65536
  s_cbranch_scc1 L_pdone_17
  s_waitcnt vmcnt(0)
  v_cmp_eq_u32 vcc, v67, v3
  s_nop 0
  s_xor_b64 vcc, vcc, s[74:75]
  s_cbranch_vccnz L_poll_16
L_pdone_17:
  s_waitcnt vmcnt(0)
  s_mov_b32 s68, 0
L_pl_18:
  buffer_load_dwordx4 v[80:83], v64, s[32:35], s56 offen offset:0 sc1
  buffer_load_dwordx4 v[84:87], v64, s[32:35], s56 offen offset:256 sc1
  buffer_load_dwordx4 v[88:91], v65, s[32:35], s56 offen offset:512 sc1
  buffer_load_dwordx4 v[92:95], v64, s[32:35], s57 offen offset:0 sc1
  buffer_load_dwordx4 v[96:99], v64, s[32:35], s57 offen offset:256 sc1
  buffer_load_dwordx4 v[100:103], v65, s[32:35], s57 offen offset:512 sc1
  buffer_load_dwordx4 v[104:107], v64, s[32:35], s58 offen offset:0 sc1
  buffer_load_dwordx4 v[108:111], v64, s[32:35], s58 offen offset:256 sc1
  buffer_load_dwordx4 v[112:115], v65, s[32:35], s58 offen offset:512 sc1
  buffer_load_dwordx4 v[116:119], v64, s[32:35], s59 offen offset:0 sc1
  buffer_load_dwordx4 v[120:123], v64, s[32:35], s59 offen offset:256 sc1
  buffer_load_dwordx4 v[124:127], v65, s[32:35], s59 offen offset:512 sc1
  s_waitcnt vmcnt(11)
  v_mfma_f32_16x16x32_bf16 v[128:131], v[68:71], v[80:83], 0
  s_waitcnt vmcnt(10)
  v_mfma_f32_16x16x32_bf16 v[132:135], v[68:71], v[84:87], 0
  s_waitcnt vmcnt(9)
  v_mfma_f32_16x16x32_bf16 v[136:139], v[68:71], v[88:91], 0
  s_waitcnt vmcnt(8)
  v_mfma_f32_16x16x32_bf16 v[128:131], v[68:71], v[92:95], v[128:131]
  s_waitcnt vmcnt(7)
  v_mfma_f32_16x16x32_bf16 v[132:135], v[68:71], v[96:99], v[132:135]
  s_waitcnt vmcnt(6)
  v_mfma_f32_16x16x32_bf16 v[136:139], v[68:71], v[100:103], v[136:139]
  s_waitcnt vmcnt(5)
  v_mfma_f32_16x16x32_bf16 v[128:131], v[68:71], v[104:107], v[128:131]
  s_waitcnt vmcnt(4)
  v_mfma_f32_16x16x32_bf16 v[132:135], v[68:71], v[108:111], v[132:135]
  s_waitcnt vmcnt(3)
  v_mfma_f32_16x16x32_bf16 v[136:139], v[68:71], v[112:115], v[136:139]
  s_waitcnt vmcnt(2)
  v_mfma_f32_16x16x32_bf16 v[128:131], v[68:71], v[116:119], v[128:131]
  s_waitcnt vmcnt(1)
  v_mfma_f32_16x16x32_bf16 v[132:135], v[68:71], v[120:123], v[132:135]
  s_waitcnt vmcnt(0)
  v_mfma_f32_16x16x32_bf16 v[136:139], v[68:71], v[124:127], v[136:139]
  s_add_u32 s68, s68, 1
  s_cmp_gt_u32 s68, 16384
  s_nop 3
  v_add_f32 v2, v128, v132
  s_nop 0
  v_cmp_u_f32 vcc, v2, v136
  s_cbranch_scc1 L_pld_19
  s_cbranch_vccnz L_pl_18
L_pld_19:
  v_cvt_pk_bf16_f32 v128, v128, v129
  v_cvt_pk_bf16_f32 v129, v130, v131
  ds_write_b32 v72, v128
  ds_write_b32 v73, v129 offset:4
  v_cvt_pk_bf16_f32 v132, v132, v133
  v_cvt_pk_bf16_f32 v133, v134, v135
  ds_write_b32 v74, v132
  ds_write_b32 v75, v133 offset:4
  v_cvt_pk_bf16_f32 v136, v136, v137
  v_cvt_pk_bf16_f32 v137, v138, v139
  ds_write_b32 v76, v136
  ds_write_b32 v77, v137 offset:4
  s_waitcnt lgkmcnt(0)
L_e4:
  s_lshl_b32 s48, s67, 2
  s_add_u32 s48, s48, s44
  s_lshl_b32 s48, s48, 5
  s_add_u32 s48, s48, s66
  s_lshl_b32 s49, s48, 7
  s_add_u32 s49, s49, 2883584
  s_lshl_b32 s48, s48, 10
  s_add_u32 s48, s48, 786432
  s_lshr_b32 s50, s3, 4
  s_or_b32 s50, s50, s71
  s_cmp_eq_u32 s50, 0
  s_barrier
  s_cbranch_scc1 L_p3
  s_setprio 2
  ds_read_b128 v[80:83], v7 offset:0
  ds_read_b128 v[84:87], v7 offset:16
  ds_read_b128 v[88:91], v7 offset:32
  ds_read_b128 v[92:95], v7 offset:1920
  ds_read_b128 v[96:99], v7 offset:1936
  ds_read_b128 v[100:103], v7 offset:1952
  s_waitcnt lgkmcnt(5)
  v_mfma_f32_32x32x16_bf16 v[32:47], v[80:83], v[8:11], 0
  s_waitcnt lgkmcnt(4)
  v_mfma_f32_32x32x16_bf16 v[32:47], v[84:87], v[12:15], v[32:47]
  s_waitcnt lgkmcnt(3)
  v_mfma_f32_32x32x16_bf16 v[32:47], v[88:91], v[16:19], v[32:47]
  s_waitcnt lgkmcnt(2)
  v_mfma_f32_32x32x16_bf16 v[48:63], v[92:95], v[18:21], 0
  s_waitcnt lgkmcnt(1)
  v_mfma_f32_32x32x16_bf16 v[48:63], v[96:99], v[22:25], v[48:63]
  s_waitcnt lgkmcnt(0)
  v_mfma_f32_32x32x16_bf16 v[48:63], v[100:103], v[26:29], v[48:63]
  s_nop 5
  v_add_f32 v42, 0x358637bd, v42
  v_rcp_f32 v42, v42
  s_nop 0
  v_mov_b32 v43, v42
  v_pk_mul_f32 v[32:33], v[32:33], v[42:43]
  v_pk_mul_f32 v[34:35], v[34:35], v[42:43]
  v_pk_mul_f32 v[36:37], v[36:37], v[42:43]
  v_pk_mul_f32 v[38:39], v[38:39], v[42:43]
  v_pk_mul_f32 v[40:41], v[40:41], v[42:43]
  v_cvt_pk_bf16_f32 v104, v32, v33
  v_cvt_pk_bf16_f32 v105, v34, v35
  v_cvt_pk_bf16_f32 v106, v36, v37
  v_cvt_pk_bf16_f32 v107, v38, v39
  v_cvt_pk_bf16_f32 v112, v40, v41
  buffer_store_dwordx4 v[104:107], v30, s[32:35], s48 offen offset:0 sc1
  v_add_f32 v58, 0x358637bd, v58
  v_rcp_f32 v58, v58
  s_nop 0
  v_mov_b32 v59, v58
  v_pk_mul_f32 v[48:49], v[48:49], v[58:59]
  v_pk_mul_f32 v[50:51], v[50:51], v[58:59]
  v_pk_mul_f32 v[52:53], v[52:53], v[58:59]
  v_pk_mul_f32 v[54:55], v[54:55], v[58:59]
  v_pk_mul_f32 v[56:57], v[56:57], v[58:59]
  v_cvt_pk_bf16_f32 v108, v48, v49
  v_cvt_pk_bf16_f32 v109, v50, v51
  v_cvt_pk_bf16_f32 v110, v52, v53
  v_cvt_pk_bf16_f32 v111, v54, v55
  v_cvt_pk_bf16_f32 v113, v56, v57
  buffer_store_dwordx4 v[108:111], v30, s[32:35], s48 offen offset:512 sc1
  buffer_store_dwordx2 v[112:113], v31, s[32:35], s49 offen sc1
  s_cmp_eq_u32 s71, 0
  s_cbranch_scc0 L_fin
L_p3:
  s_mov_b32 s36, s10
  s_and_b32 s37, s11, 0xffff
  s_mov_b32 s38, 663552
  s_mov_b32 s39, 0x20000
  v_add_u32 v2, 0, v1
  v_mul_u32_u24 v3, 171, v2
  v_lshrrev_b32 v3, 11, v3
  v_mul_u32_u24 v4, 12, v3
  v_sub_u32 v2, v2, v4
  v_lshrrev_b32 v4, 2, v3
  v_and_b32 v4, 2, v4
  v_xor_b32 v2, v2, v4
  v_mul_u32_u24 v3, 1152, v3
  v_lshl_add_u32 v7, v2, 4, v3
  v_add_u32 v2, 64, v1
  v_mul_u32_u24 v3, 171, v2
  v_lshrrev_b32 v3, 11, v3
  v_mul_u32_u24 v4, 12, v3
  v_sub_u32 v2, v2, v4
  v_lshrrev_b32 v4, 2, v3
  v_and_b32 v4, 2, v4
  v_xor_b32 v2, v2, v4
  v_mul_u32_u24 v3, 1152, v3
  v_lshl_add_u32 v8, v2, 4, v3
  v_add_u32 v2, 128, v1
  v_mul_u32_u24 v3, 171, v2
  v_lshrrev_b32 v3, 11, v3
  v_mul_u32_u24 v4, 12, v3
  v_sub_u32 v2, v2, v4
  v_lshrrev_b32 v4, 2, v3
  v_and_b32 v4, 2, v4
  v_xor_b32 v2, v2, v4
  v_mul_u32_u24 v3, 1152, v3
  v_lshl_add_u32 v9, v2, 4, v3
  s_lshr_b32 s48, s3, 2
  s_mul_i32 s69, s48, 192
  s_mul_i32 s48, s44, 18432
  s_add_u32 s69, s69, s48
  s_mul_i32 s70, s44, 3072
  s_add_u32 s69, s69, 368640
  s_mov_b32 s40, s20
  s_and_b32 s41, s21, 0xffff
  s_mov_b32 s42, 4718592
  s_mov_b32 s43, 0x20000
  v_lshrrev_b32 v2, 5, v1
  v_mul_u32_u24 v2, 18, v2
  v_bfe_u32 v3, v1, 4, 1
  v_lshl_add_u32 v2, v3, 3, v2
  v_bfe_u32 v3, v1, 2, 2
  v_add_u32 v2, v2, v3
  v_and_b32 v5, 3, v1
  v_lshlrev_b32 v5, 3, v5
  v_mul_u32_u24 v3, 192, v2
  v_add_u32 v3, v3, v5
  v_add_u32 v4, 0, v2
  v_and_b32 v4, 8, v4
  v_lshl_add_u32 v10, v4, 2, v3
  v_xor_b32 v11, 32, v10
  v_add_u32 v4, 4, v2
  v_and_b32 v4, 8, v4
  v_lshl_add_u32 v12, v4, 2, v3
  v_xor_b32 v13, 32, v12
  v_add_u32 v4, 8, v2
  v_and_b32 v4, 8, v4
  v_lshl_add_u32 v14, v4, 2, v3
  v_xor_b32 v15, 32, v14
  v_add_u32 v4, 12, v2
  v_and_b32 v4, 8, v4
  v_lshl_add_u32 v16, v4, 2, v3
  v_xor_b32 v17, 32, v16
  v_lshrrev_b32 v2, 4, v1
  v_mul_u32_u24 v2, 72, v2
  v_bfe_u32 v3, v1, 3, 1
  v_mad_u32_u24 v2, v3, 18, v2
  v_bfe_u32 v3, v1, 2, 1
  v_add3_u32 v2, v2, v3, 16
  v_mul_u32_u24 v3, 192, v2
  v_add_u32 v3, v3, v5
  v_and_b32 v4, 8, v2
  v_lshl_add_u32 v18, v4, 2, v3
  v_xor_b32 v19, 32, v18
  v_add_u32 v2, 36, v2
  v_mul_u32_u24 v3, 192, v2
  v_add_u32 v3, v3, v5
  v_and_b32 v4, 8, v2
  v_lshl_add_u32 v20, v4, 2, v3
  v_xor_b32 v21, 32, v20
  s_lshl_b32 s54, s45, 2
  s_and_b32 s48, s3, 3
  s_add_u32 s54, s54, s48
  s_lshl_b32 s54, s54, 2
  s_add_u32 s54, s54, s44
  s_lshl_b32 s52, s54, 11
  s_add_u32 s52, s52, 2883584
  s_lshl_b32 s53, s54, 14
  s_add_u32 s53, s53, 786432
  v_and_b32 v2, 15, v1
  v_mul_u32_u24 v2, 2304, v2
  v_bfe_u32 v3, v1, 4, 1
  v_lshl_add_u32 v2, v3, 5, v2
  v_lshrrev_b32 v3, 5, v1
  v_lshl_add_u32 v240, v3, 4, v2
  s_mul_i32 s55, s54, 36864
  s_lshr_b32 s49, s3, 2
  s_mul_i32 s49, s49, 192
  s_add_u32 s55, s55, s49
  v_lshlrev_b32 v22, 4, v1
  v_and_b32 v3, 15, v1
  v_lshrrev_b32 v4, 4, v1
  v_lshlrev_b32 v4, 8, v4
  v_lshl_add_u32 v23, v3, 3, v4
  s_lshr_b32 s48, s54, 1
  s_lshl_b32 s48, s48, 11
  s_add_u32 s48, s48, 3252224
  s_mov_b32 s74, 0xffff0000
  s_mov_b32 s75, -1
  v_and_b32 v254, 15, v1
  v_mul_u32_u24 v2, 128, v254
  v_add_u32 v2, s52, v2
  v_lshl_add_u32 v254, v254, 7, s48
  v_cndmask_b32 v2, v2, v254, s[74:75]
  v_mov_b32 v254, s72
  v_cndmask_b32 v4, -1, v254, s[74:75]
  s_add_u32 s48, s53, 4096
  s_add_u32 s49, s53, 8192
  s_add_u32 s50, s53, 12288
  s_mov_b32 s51, 0
  ds_read_b64_tr_b16 v[24:25], v10 offset:0
  ds_read_b64_tr_b16 v[26:27], v12 offset:768
  ds_read_b64_tr_b16 v[28:29], v11 offset:0
  ds_read_b64_tr_b16 v[30:31], v13 offset:768
  ds_read_b64_tr_b16 v[32:33], v10 offset:64
  ds_read_b64_tr_b16 v[34:35], v12 offset:832
  ds_read_b64_tr_b16 v[36:37], v11 offset:64
  ds_read_b64_tr_b16 v[38:39], v13 offset:832
  ds_read_b64_tr_b16 v[40:41], v10 offset:128
  ds_read_b64_tr_b16 v[42:43], v12 offset:896
  ds_read_b64_tr_b16 v[44:45], v11 offset:128
  ds_read_b64_tr_b16 v[46:47], v13 offset:896
  s_waitcnt lgkmcnt(0)
  ds_read_b64_tr_b16 v[48:49], v12 offset:6912
  ds_read_b64_tr_b16 v[50:51], v14 offset:7680
  ds_read_b64_tr_b16 v[52:53], v13 offset:6912
  ds_read_b64_tr_b16 v[54:55], v15 offset:7680
  ds_read_b64_tr_b16 v[56:57], v12 offset:6976
  ds_read_b64_tr_b16 v[58:59], v14 offset:7744
  ds_read_b64_tr_b16 v[60:61], v13 offset:6976
  ds_read_b64_tr_b16 v[62:63], v15 offset:7744
  ds_read_b64_tr_b16 v[64:65], v12 offset:7040
  ds_read_b64_tr_b16 v[66:67], v14 offset:7808
  ds_read_b64_tr_b16 v[68:69], v13 offset:7040
  ds_read_b64_tr_b16 v[70:71], v15 offset:7808
  s_waitcnt lgkmcnt(0)
  s_add_u32 m0, s70, 61440
  s_nop 0
  buffer_load_dwordx4 v7, s[36:39], s69 offen lds
  s_add_u32 m0, s70, 62464
  s_nop 0
  buffer_load_dwordx4 v8, s[36:39], s69 offen lds
  s_add_u32 m0, s70, 63488
  s_nop 0
  buffer_load_dwordx4 v9, s[36:39], s69 offen lds
  s_add_u32 s69, s69, 73728
  s_add_u32 m0, s70, 73728
  s_nop 0
  buffer_load_dwordx4 v7, s[36:39], s69 offen lds
  s_add_u32 m0, s70, 74752
  s_nop 0
  buffer_load_dwordx4 v8, s[36:39], s69 offen lds
  s_add_u32 m0, s70, 75776
  s_nop 0
  buffer_load_dwordx4 v9, s[36:39], s69 offen lds
  s_add_u32 s69, s69, 73728
  s_add_u32 m0, s70, 86016
  s_nop 0
  buffer_load_dwordx4 v7, s[36:39], s69 offen lds
  s_add_u32 m0, s70, 87040
  s_nop 0
  buffer_load_dwordx4 v8, s[36:39], s69 offen lds
  s_add_u32 m0, s70, 88064
  s_nop 0
  buffer_load_dwordx4 v9, s[36:39], s69 offen lds
  s_add_u32 s69, s69, 73728
  s_add_u32 m0, s70, 98304
  s_nop 0
  buffer_load_dwordx4 v7, s[36:39], s69 offen lds
  s_add_u32 m0, s70, 99328
  s_nop 0
  buffer_load_dwordx4 v8, s[36:39], s69 offen lds
  s_add_u32 m0, s70, 100352
  s_nop 0
  buffer_load_dwordx4 v9, s[36:39], s69 offen lds
  s_add_u32 s69, s69, 73728
  buffer_load_dword v253, v2, s[32:35], 0 offen sc1
  s_lshl_b32 s69, s44, 2
  s_add_u32 s69, s69, 158704
  ds_read_b64_tr_b16 v[72:73], v14 offset:13824
  ds_read_b64_tr_b16 v[74:75], v16 offset:14592
  ds_read_b64_tr_b16 v[76:77], v15 offset:13824
  ds_read_b64_tr_b16 v[78:79], v17 offset:14592
  ds_read_b64_tr_b16 v[80:81], v14 offset:13888
  ds_read_b64_tr_b16 v[82:83], v16 offset:14656
  ds_read_b64_tr_b16 v[84:85], v15 offset:13888
  ds_read_b64_tr_b16 v[86:87], v17 offset:14656
  ds_read_b64_tr_b16 v[88:89], v14 offset:13952
  ds_read_b64_tr_b16 v[90:91], v16 offset:14720
  ds_read_b64_tr_b16 v[92:93], v15 offset:13952
  ds_read_b64_tr_b16 v[94:95], v17 offset:14720
  s_waitcnt lgkmcnt(0)
  ds_read_b64_tr_b16 v[96:97], v16 offset:20736
  ds_read_b64_tr_b16 v[98:99], v10 offset:21504
  ds_read_b64_tr_b16 v[100:101], v17 offset:20736
  ds_read_b64_tr_b16 v[102:103], v11 offset:21504
  ds_read_b64_tr_b16 v[104:105], v16 offset:20800
  ds_read_b64_tr_b16 v[106:107], v10 offset:21568
  ds_read_b64_tr_b16 v[108:109], v17 offset:20800
  ds_read_b64_tr_b16 v[110:111], v11 offset:21568
  ds_read_b64_tr_b16 v[112:113], v16 offset:20864
  ds_read_b64_tr_b16 v[114:115], v10 offset:21632
  ds_read_b64_tr_b16 v[116:117], v17 offset:20864
  ds_read_b64_tr_b16 v[118:119], v11 offset:21632
  s_waitcnt lgkmcnt(0)
  ds_read_b64_tr_b16 v[120:121], v10 offset:27648
  ds_read_b64_tr_b16 v[122:123], v12 offset:28416
  ds_read_b64_tr_b16 v[124:125], v11 offset:27648
  ds_read_b64_tr_b16 v[126:127], v13 offset:28416
  ds_read_b64_tr_b16 v[128:129], v10 offset:27712
  ds_read_b64_tr_b16 v[130:131], v12 offset:28480
  ds_read_b64_tr_b16 v[132:133], v11 offset:27712
  ds_read_b64_tr_b16 v[134:135], v13 offset:28480
  ds_read_b64_tr_b16 v[136:137], v10 offset:27776
  ds_read_b64_tr_b16 v[138:139], v12 offset:28544
  ds_read_b64_tr_b16 v[140:141], v11 offset:27776
  ds_read_b64_tr_b16 v[142:143], v13 offset:28544
  s_waitcnt lgkmcnt(0)
  s_waitcnt vmcnt(1)
  v_mov_b32 v254, s69
  v_mov_b32 v255, 1
  ds_write_b32 v254, v255
L_s3_20:
  s_mov_b32 s68, 0
L_poll_22:
  buffer_load_dword v3, v2, s[32:35], 0 offen sc1
  s_add_u32 s68, s68, 1
  s_cmp_gt_u32 s68, 65536
  s_cbranch_scc1 L_pdone_23
  s_waitcnt vmcnt(0)
  v_cmp_eq_u32 vcc, v4, v3
  s_nop 0
  s_xor_b64 vcc, vcc, s[74:75]
  s_cbranch_vccnz L_poll_22
L_pdone_23:
  s_waitcnt vmcnt(0)
  buffer_load_dwordx4 v[144:147], v22, s[32:35], s53 offen offset:0 sc1
  buffer_load_dwordx4 v[148:151], v22, s[32:35], s53 offen offset:1024 sc1
  buffer_load_dwordx4 v[152:155], v22, s[32:35], s53 offen offset:2048 sc1
  buffer_load_dwordx4 v[156:159], v22, s[32:35], s53 offen offset:3072 sc1
  buffer_load_dwordx4 v[160:163], v22, s[32:35], s48 offen offset:0 sc1
  buffer_load_dwordx4 v[164:167], v22, s[32:35], s48 offen offset:1024 sc1
  buffer_load_dwordx4 v[168:171], v22, s[32:35], s48 offen offset:2048 sc1
  buffer_load_dwordx4 v[172:175], v22, s[32:35], s48 offen offset:3072 sc1
  buffer_load_dwordx4 v[176:179], v22, s[32:35], s49 offen offset:0 sc1
  buffer_load_dwordx4 v[180:183], v22, s[32:35], s49 offen offset:1024 sc1
  buffer_load_dwordx4 v[184:187], v22, s[32:35], s49 offen offset:2048 sc1
  buffer_load_dwordx4 v[188:191], v22, s[32:35], s49 offen offset:3072 sc1
  buffer_load_dwordx4 v[192:195], v22, s[32:35], s50 offen offset:0 sc1
  buffer_load_dwordx4 v[196:199], v22, s[32:35], s50 offen offset:1024 sc1
  buffer_load_dwordx4 v[200:203], v22, s[32:35], s50 offen offset:2048 sc1
  buffer_load_dwordx4 v[204:207], v22, s[32:35], s50 offen offset:3072 sc1
  buffer_load_dwordx2 v[208:209], v23, s[32:35], s52 offen offset:0 sc1
  buffer_load_dwordx2 v[210:211], v23, s[32:35], s52 offen offset:128 sc1
  buffer_load_dwordx2 v[212:213], v23, s[32:35], s52 offen offset:1024 sc1
  buffer_load_dwordx2 v[214:215], v23, s[32:35], s52 offen offset:1152 sc1
  v_mov_b32 v254, 158624
  s_mov_b32 s68, 0
L_lf_24:
  ds_read_b128 v[216:219], v254 offset:80
  s_add_u32 s68, s68, 1
  s_cmp_gt_u32 s68, 1048576
  s_waitcnt lgkmcnt(0)
  v_min3_u32 v216, v216, v217, v218
  v_min_u32 v216, v216, v219
  v_cmp_eq_u32 vcc, 0, v216
  s_cbranch_scc1 L_lfd_25
  s_cbranch_vccnz L_lf_24
L_lfd_25:
  s_waitcnt vmcnt(19) lgkmcnt(0)
  v_mfma_f32_16x16x32_bf16 v[216:219], v[24:27], v[144:147], 0
  v_mfma_f32_16x16x32_bf16 v[220:223], v[28:31], v[144:147], 0
  v_mfma_f32_16x16x32_bf16 v[224:227], v[32:35], v[144:147], 0
  v_mfma_f32_16x16x32_bf16 v[228:231], v[36:39], v[144:147], 0
  v_mfma_f32_16x16x32_bf16 v[232:235], v[40:43], v[144:147], 0
  v_mfma_f32_16x16x32_bf16 v[236:239], v[44:47], v[144:147], 0
  s_waitcnt vmcnt(18) lgkmcnt(3)
  v_mfma_f32_16x16x32_bf16 v[216:219], v[48:51], v[148:151], v[216:219]
  ds_read_b64_tr_b16 v[24:25], v12 offset:34560
  ds_read_b64_tr_b16 v[26:27], v14 offset:35328
  v_mfma_f32_16x16x32_bf16 v[220:223], v[52:55], v[148:151], v[220:223]
  ds_read_b64_tr_b16 v[28:29], v13 offset:34560
  ds_read_b64_tr_b16 v[30:31], v15 offset:35328
  v_mfma_f32_16x16x32_bf16 v[224:227], v[56:59], v[148:151], v[224:227]
  ds_read_b64_tr_b16 v[32:33], v12 offset:34624
  ds_read_b64_tr_b16 v[34:35], v14 offset:35392
  v_mfma_f32_16x16x32_bf16 v[228:231], v[60:63], v[148:151], v[228:231]
  ds_read_b64_tr_b16 v[36:37], v13 offset:34624
  ds_read_b64_tr_b16 v[38:39], v15 offset:35392
  v_mfma_f32_16x16x32_bf16 v[232:235], v[64:67], v[148:151], v[232:235]
  ds_read_b64_tr_b16 v[40:41], v12 offset:34688
  ds_read_b64_tr_b16 v[42:43], v14 offset:35456
  v_mfma_f32_16x16x32_bf16 v[236:239], v[68:71], v[148:151], v[236:239]
  ds_read_b64_tr_b16 v[44:45], v13 offset:34688
  ds_read_b64_tr_b16 v[46:47], v15 offset:35456
  s_waitcnt vmcnt(17) lgkmcnt(3)
  v_mfma_f32_16x16x32_bf16 v[216:219], v[72:75], v[152:155], v[216:219]
  ds_read_b64_tr_b16 v[48:49], v14 offset:41472
  ds_read_b64_tr_b16 v[50:51], v16 offset:42240
  v_mfma_f32_16x16x32_bf16 v[220:223], v[76:79], v[152:155], v[220:223]
  ds_read_b64_tr_b16 v[52:53], v15 offset:41472
  ds_read_b64_tr_b16 v[54:55], v17 offset:42240
  v_mfma_f32_16x16x32_bf16 v[224:227], v[80:83], v[152:155], v[224:227]
  ds_read_b64_tr_b16 v[56:57], v14 offset:41536
  ds_read_b64_tr_b16 v[58:59], v16 offset:42304
  v_mfma_f32_16x16x32_bf16 v[228:231], v[84:87], v[152:155], v[228:231]
  ds_read_b64_tr_b16 v[60:61], v15 offset:41536
  ds_read_b64_tr_b16 v[62:63], v17 offset:42304
  v_mfma_f32_16x16x32_bf16 v[232:235], v[88:91], v[152:155], v[232:235]
  ds_read_b64_tr_b16 v[64:65], v14 offset:41600
  ds_read_b64_tr_b16 v[66:67], v16 offset:42368
  v_mfma_f32_16x16x32_bf16 v[236:239], v[92:95], v[152:155], v[236:239]
  ds_read_b64_tr_b16 v[68:69], v15 offset:41600
  ds_read_b64_tr_b16 v[70:71], v17 offset:42368
  s_waitcnt vmcnt(16) lgkmcnt(3)
  v_mfma_f32_16x16x32_bf16 v[216:219], v[96:99], v[156:159], v[216:219]
  ds_read_b64_tr_b16 v[72:73], v16 offset:48384
  ds_read_b64_tr_b16 v[74:75], v10 offset:49152
  v_mfma_f32_16x16x32_bf16 v[220:223], v[100:103], v[156:159], v[220:223]
  ds_read_b64_tr_b16 v[76:77], v17 offset:48384
  ds_read_b64_tr_b16 v[78:79], v11 offset:49152
  v_mfma_f32_16x16x32_bf16 v[224:227], v[104:107], v[156:159], v[224:227]
  ds_read_b64_tr_b16 v[80:81], v16 offset:48448
  ds_read_b64_tr_b16 v[82:83], v10 offset:49216
  v_mfma_f32_16x16x32_bf16 v[228:231], v[108:111], v[156:159], v[228:231]
  ds_read_b64_tr_b16 v[84:85], v17 offset:48448
  ds_read_b64_tr_b16 v[86:87], v11 offset:49216
  v_mfma_f32_16x16x32_bf16 v[232:235], v[112:115], v[156:159], v[232:235]
  ds_read_b64_tr_b16 v[88:89], v16 offset:48512
  ds_read_b64_tr_b16 v[90:91], v10 offset:49280
  v_mfma_f32_16x16x32_bf16 v[236:239], v[116:119], v[156:159], v[236:239]
  ds_read_b64_tr_b16 v[92:93], v17 offset:48512
  ds_read_b64_tr_b16 v[94:95], v11 offset:49280
  s_waitcnt vmcnt(15) lgkmcnt(3)
  v_mfma_f32_16x16x32_bf16 v[216:219], v[120:123], v[160:163], v[216:219]
  v_add_u32 v10, 55296, v10
  v_add_u32 v11, 55296, v11
  v_add_u32 v12, 55296, v12
  v_add_u32 v13, 55296, v13
  v_add_u32 v14, 55296, v14
  v_add_u32 v15, 55296, v15
  v_add_u32 v16, 55296, v16
  v_add_u32 v17, 55296, v17
  ds_read_b64_tr_b16 v[96:97], v10 offset:0
  ds_read_b64_tr_b16 v[98:99], v12 offset:768
  v_mfma_f32_16x16x32_bf16 v[220:223], v[124:127], v[160:163], v[220:223]
  ds_read_b64_tr_b16 v[100:101], v11 offset:0
  ds_read_b64_tr_b16 v[102:103], v13 offset:768
  v_mfma_f32_16x16x32_bf16 v[224:227], v[128:131], v[160:163], v[224:227]
  ds_read_b64_tr_b16 v[104:105], v10 offset:64
  ds_read_b64_tr_b16 v[106:107], v12 offset:832
  v_mfma_f32_16x16x32_bf16 v[228:231], v[132:135], v[160:163], v[228:231]
  ds_read_b64_tr_b16 v[108:109], v11 offset:64
  ds_read_b64_tr_b16 v[110:111], v13 offset:832
  v_mfma_f32_16x16x32_bf16 v[232:235], v[136:139], v[160:163], v[232:235]
  ds_read_b64_tr_b16 v[112:113], v10 offset:128
  ds_read_b64_tr_b16 v[114:115], v12 offset:896
  v_mfma_f32_16x16x32_bf16 v[236:239], v[140:143], v[160:163], v[236:239]
  ds_read_b64_tr_b16 v[116:117], v11 offset:128
  ds_read_b64_tr_b16 v[118:119], v13 offset:896
  s_waitcnt vmcnt(14) lgkmcnt(3)
  v_mfma_f32_16x16x32_bf16 v[216:219], v[24:27], v[164:167], v[216:219]
  ds_read_b64_tr_b16 v[120:121], v12 offset:6912
  ds_read_b64_tr_b16 v[122:123], v14 offset:7680
  v_mfma_f32_16x16x32_bf16 v[220:223], v[28:31], v[164:167], v[220:223]
  ds_read_b64_tr_b16 v[124:125], v13 offset:6912
  ds_read_b64_tr_b16 v[126:127], v15 offset:7680
  v_mfma_f32_16x16x32_bf16 v[224:227], v[32:35], v[164:167], v[224:227]
  ds_read_b64_tr_b16 v[128:129], v12 offset:6976
  ds_read_b64_tr_b16 v[130:131], v14 offset:7744
  v_mfma_f32_16x16x32_bf16 v[228:231], v[36:39], v[164:167], v[228:231]
  ds_read_b64_tr_b16 v[132:133], v13 offset:6976
  ds_read_b64_tr_b16 v[134:135], v15 offset:7744
  v_mfma_f32_16x16x32_bf16 v[232:235], v[40:43], v[164:167], v[232:235]
  ds_read_b64_tr_b16 v[136:137], v12 offset:7040
  ds_read_b64_tr_b16 v[138:139], v14 offset:7808
  v_mfma_f32_16x16x32_bf16 v[236:239], v[44:47], v[164:167], v[236:239]
  ds_read_b64_tr_b16 v[140:141], v13 offset:7040
  ds_read_b64_tr_b16 v[142:143], v15 offset:7808
  s_waitcnt vmcnt(13) lgkmcnt(3)
  v_mfma_f32_16x16x32_bf16 v[216:219], v[48:51], v[168:171], v[216:219]
  ds_read_b64_tr_b16 v[24:25], v14 offset:13824
  ds_read_b64_tr_b16 v[26:27], v16 offset:14592
  v_mfma_f32_16x16x32_bf16 v[220:223], v[52:55], v[168:171], v[220:223]
  ds_read_b64_tr_b16 v[28:29], v15 offset:13824
  ds_read_b64_tr_b16 v[30:31], v17 offset:14592
  v_mfma_f32_16x16x32_bf16 v[224:227], v[56:59], v[168:171], v[224:227]
  ds_read_b64_tr_b16 v[32:33], v14 offset:13888
  ds_read_b64_tr_b16 v[34:35], v16 offset:14656
  v_mfma_f32_16x16x32_bf16 v[228:231], v[60:63], v[168:171], v[228:231]
  ds_read_b64_tr_b16 v[36:37], v15 offset:13888
  ds_read_b64_tr_b16 v[38:39], v17 offset:14656
  v_mfma_f32_16x16x32_bf16 v[232:235], v[64:67], v[168:171], v[232:235]
  ds_read_b64_tr_b16 v[40:41], v14 offset:13952
  ds_read_b64_tr_b16 v[42:43], v16 offset:14720
  v_mfma_f32_16x16x32_bf16 v[236:239], v[68:71], v[168:171], v[236:239]
  ds_read_b64_tr_b16 v[44:45], v15 offset:13952
  ds_read_b64_tr_b16 v[46:47], v17 offset:14720
  s_waitcnt vmcnt(12) lgkmcnt(3)
  v_mfma_f32_16x16x32_bf16 v[216:219], v[72:75], v[172:175], v[216:219]
  ds_read_b64_tr_b16 v[48:49], v16 offset:20736
  ds_read_b64_tr_b16 v[50:51], v10 offset:21504
  v_mfma_f32_16x16x32_bf16 v[220:223], v[76:79], v[172:175], v[220:223]
  ds_read_b64_tr_b16 v[52:53], v17 offset:20736
  ds_read_b64_tr_b16 v[54:55], v11 offset:21504
  v_mfma_f32_16x16x32_bf16 v[224:227], v[80:83], v[172:175], v[224:227]
  ds_read_b64_tr_b16 v[56:57], v16 offset:20800
  ds_read_b64_tr_b16 v[58:59], v10 offset:21568
  v_mfma_f32_16x16x32_bf16 v[228:231], v[84:87], v[172:175], v[228:231]
  ds_read_b64_tr_b16 v[60:61], v17 offset:20800
  ds_read_b64_tr_b16 v[62:63], v11 offset:21568
  v_mfma_f32_16x16x32_bf16 v[232:235], v[88:91], v[172:175], v[232:235]
  ds_read_b64_tr_b16 v[64:65], v16 offset:20864
  ds_read_b64_tr_b16 v[66:67], v10 offset:21632
  v_mfma_f32_16x16x32_bf16 v[236:239], v[92:95], v[172:175], v[236:239]
  ds_read_b64_tr_b16 v[68:69], v17 offset:20864
  ds_read_b64_tr_b16 v[70:71], v11 offset:21632
  s_waitcnt vmcnt(11) lgkmcnt(3)
  v_mfma_f32_16x16x32_bf16 v[216:219], v[96:99], v[176:179], v[216:219]
  ds_read_b64_tr_b16 v[72:73], v10 offset:27648
  ds_read_b64_tr_b16 v[74:75], v12 offset:28416
  v_mfma_f32_16x16x32_bf16 v[220:223], v[100:103], v[176:179], v[220:223]
  ds_read_b64_tr_b16 v[76:77], v11 offset:27648
  ds_read_b64_tr_b16 v[78:79], v13 offset:28416
  v_mfma_f32_16x16x32_bf16 v[224:227], v[104:107], v[176:179], v[224:227]
  ds_read_b64_tr_b16 v[80:81], v10 offset:27712
  ds_read_b64_tr_b16 v[82:83], v12 offset:28480
  v_mfma_f32_16x16x32_bf16 v[228:231], v[108:111], v[176:179], v[228:231]
  ds_read_b64_tr_b16 v[84:85], v11 offset:27712
  ds_read_b64_tr_b16 v[86:87], v13 offset:28480
  v_mfma_f32_16x16x32_bf16 v[232:235], v[112:115], v[176:179], v[232:235]
  ds_read_b64_tr_b16 v[88:89], v10 offset:27776
  ds_read_b64_tr_b16 v[90:91], v12 offset:28544
  v_mfma_f32_16x16x32_bf16 v[236:239], v[116:119], v[176:179], v[236:239]
  ds_read_b64_tr_b16 v[92:93], v11 offset:27776
  ds_read_b64_tr_b16 v[94:95], v13 offset:28544
  s_waitcnt vmcnt(10) lgkmcnt(3)
  v_mfma_f32_16x16x32_bf16 v[216:219], v[120:123], v[180:183], v[216:219]
  ds_read_b64_tr_b16 v[96:97], v12 offset:34560
  ds_read_b64_tr_b16 v[98:99], v14 offset:35328
  v_mfma_f32_16x16x32_bf16 v[220:223], v[124:127], v[180:183], v[220:223]
  ds_read_b64_tr_b16 v[100:101], v13 offset:34560
  ds_read_b64_tr_b16 v[102:103], v15 offset:35328
  v_mfma_f32_16x16x32_bf16 v[224:227], v[128:131], v[180:183], v[224:227]
  ds_read_b64_tr_b16 v[104:105], v12 offset:34624
  ds_read_b64_tr_b16 v[106:107], v14 offset:35392
  v_mfma_f32_16x16x32_bf16 v[228:231], v[132:135], v[180:183], v[228:231]
  ds_read_b64_tr_b16 v[108:109], v13 offset:34624
  ds_read_b64_tr_b16 v[110:111], v15 offset:35392
  v_mfma_f32_16x16x32_bf16 v[232:235], v[136:139], v[180:183], v[232:235]
  ds_read_b64_tr_b16 v[112:113], v12 offset:34688
  ds_read_b64_tr_b16 v[114:115], v14 offset:35456
  v_mfma_f32_16x16x32_bf16 v[236:239], v[140:143], v[180:183], v[236:239]
  ds_read_b64_tr_b16 v[116:117], v13 offset:34688
  ds_read_b64_tr_b16 v[118:119], v15 offset:35456
  s_waitcnt vmcnt(9) lgkmcnt(3)
  v_mfma_f32_16x16x32_bf16 v[216:219], v[24:27], v[184:187], v[216:219]
  ds_read_b64_tr_b16 v[120:121], v14 offset:41472
  ds_read_b64_tr_b16 v[122:123], v16 offset:42240
  v_mfma_f32_16x16x32_bf16 v[220:223], v[28:31], v[184:187], v[220:223]
  ds_read_b64_tr_b16 v[124:125], v15 offset:41472
  ds_read_b64_tr_b16 v[126:127], v17 offset:42240
  v_mfma_f32_16x16x32_bf16 v[224:227], v[32:35], v[184:187], v[224:227]
  ds_read_b64_tr_b16 v[128:129], v14 offset:41536
  ds_read_b64_tr_b16 v[130:131], v16 offset:42304
  v_mfma_f32_16x16x32_bf16 v[228:231], v[36:39], v[184:187], v[228:231]
  ds_read_b64_tr_b16 v[132:133], v15 offset:41536
  ds_read_b64_tr_b16 v[134:135], v17 offset:42304
  v_mfma_f32_16x16x32_bf16 v[232:235], v[40:43], v[184:187], v[232:235]
  ds_read_b64_tr_b16 v[136:137], v14 offset:41600
  ds_read_b64_tr_b16 v[138:139], v16 offset:42368
  v_mfma_f32_16x16x32_bf16 v[236:239], v[44:47], v[184:187], v[236:239]
  ds_read_b64_tr_b16 v[140:141], v15 offset:41600
  ds_read_b64_tr_b16 v[142:143], v17 offset:42368
  s_waitcnt vmcnt(8) lgkmcnt(3)
  v_mfma_f32_16x16x32_bf16 v[216:219], v[48:51], v[188:191], v[216:219]
  ds_read_b64_tr_b16 v[24:25], v16 offset:48384
  ds_read_b64_tr_b16 v[26:27], v10 offset:49152
  v_mfma_f32_16x16x32_bf16 v[220:223], v[52:55], v[188:191], v[220:223]
  ds_read_b64_tr_b16 v[28:29], v17 offset:48384
  ds_read_b64_tr_b16 v[30:31], v11 offset:49152
  v_mfma_f32_16x16x32_bf16 v[224:227], v[56:59], v[188:191], v[224:227]
  ds_read_b64_tr_b16 v[32:33], v16 offset:48448
  ds_read_b64_tr_b16 v[34:35], v10 offset:49216
  v_mfma_f32_16x16x32_bf16 v[228:231], v[60:63], v[188:191], v[228:231]
  ds_read_b64_tr_b16 v[36:37], v17 offset:48448
  ds_read_b64_tr_b16 v[38:39], v11 offset:49216
  v_mfma_f32_16x16x32_bf16 v[232:235], v[64:67], v[188:191], v[232:235]
  ds_read_b64_tr_b16 v[40:41], v16 offset:48512
  ds_read_b64_tr_b16 v[42:43], v10 offset:49280
  v_mfma_f32_16x16x32_bf16 v[236:239], v[68:71], v[188:191], v[236:239]
  ds_read_b64_tr_b16 v[44:45], v17 offset:48512
  ds_read_b64_tr_b16 v[46:47], v11 offset:49280
  s_waitcnt vmcnt(7) lgkmcnt(3)
  v_mfma_f32_16x16x32_bf16 v[216:219], v[72:75], v[192:195], v[216:219]
  ds_read_b64_tr_b16 v[48:49], v18 offset:0
  ds_read_b64_tr_b16 v[50:51], v20 offset:0
  v_mfma_f32_16x16x32_bf16 v[220:223], v[76:79], v[192:195], v[220:223]
  ds_read_b64_tr_b16 v[52:53], v19 offset:0
  ds_read_b64_tr_b16 v[54:55], v21 offset:0
  v_mfma_f32_16x16x32_bf16 v[224:227], v[80:83], v[192:195], v[224:227]
  ds_read_b64_tr_b16 v[56:57], v18 offset:64
  ds_read_b64_tr_b16 v[58:59], v20 offset:64
  v_mfma_f32_16x16x32_bf16 v[228:231], v[84:87], v[192:195], v[228:231]
  ds_read_b64_tr_b16 v[60:61], v19 offset:64
  ds_read_b64_tr_b16 v[62:63], v21 offset:64
  v_mfma_f32_16x16x32_bf16 v[232:235], v[88:91], v[192:195], v[232:235]
  ds_read_b64_tr_b16 v[64:65], v18 offset:128
  ds_read_b64_tr_b16 v[66:67], v20 offset:128
  v_mfma_f32_16x16x32_bf16 v[236:239], v[92:95], v[192:195], v[236:239]
  ds_read_b64_tr_b16 v[68:69], v19 offset:128
  ds_read_b64_tr_b16 v[70:71], v21 offset:128
  s_waitcnt vmcnt(6) lgkmcnt(3)
  v_mfma_f32_16x16x32_bf16 v[216:219], v[96:99], v[196:199], v[216:219]
  ds_read_b64_tr_b16 v[72:73], v18 offset:55296
  ds_read_b64_tr_b16 v[74:75], v20 offset:55296
  v_mfma_f32_16x16x32_bf16 v[220:223], v[100:103], v[196:199], v[220:223]
  ds_read_b64_tr_b16 v[76:77], v19 offset:55296
  ds_read_b64_tr_b16 v[78:79], v21 offset:55296
  v_mfma_f32_16x16x32_bf16 v[224:227], v[104:107], v[196:199], v[224:227]
  ds_read_b64_tr_b16 v[80:81], v18 offset:55360
  ds_read_b64_tr_b16 v[82:83], v20 offset:55360
  v_mfma_f32_16x16x32_bf16 v[228:231], v[108:111], v[196:199], v[228:231]
  ds_read_b64_tr_b16 v[84:85], v19 offset:55360
  ds_read_b64_tr_b16 v[86:87], v21 offset:55360
  v_mfma_f32_16x16x32_bf16 v[232:235], v[112:115], v[196:199], v[232:235]
  ds_read_b64_tr_b16 v[88:89], v18 offset:55424
  ds_read_b64_tr_b16 v[90:91], v20 offset:55424
  v_mfma_f32_16x16x32_bf16 v[236:239], v[116:119], v[196:199], v[236:239]
  ds_read_b64_tr_b16 v[92:93], v19 offset:55424
  ds_read_b64_tr_b16 v[94:95], v21 offset:55424
  s_waitcnt vmcnt(5) lgkmcnt(0)
  v_mfma_f32_16x16x32_bf16 v[216:219], v[120:123], v[200:203], v[216:219]
  v_mfma_f32_16x16x32_bf16 v[220:223], v[124:127], v[200:203], v[220:223]
  v_mfma_f32_16x16x32_bf16 v[224:227], v[128:131], v[200:203], v[224:227]
  v_mfma_f32_16x16x32_bf16 v[228:231], v[132:135], v[200:203], v[228:231]
  v_mfma_f32_16x16x32_bf16 v[232:235], v[136:139], v[200:203], v[232:235]
  v_mfma_f32_16x16x32_bf16 v[236:239], v[140:143], v[200:203], v[236:239]
  s_waitcnt vmcnt(4) lgkmcnt(0)
  v_mfma_f32_16x16x32_bf16 v[216:219], v[24:27], v[204:207], v[216:219]
  v_mfma_f32_16x16x32_bf16 v[220:223], v[28:31], v[204:207], v[220:223]
  v_mfma_f32_16x16x32_bf16 v[224:227], v[32:35], v[204:207], v[224:227]
  v_mfma_f32_16x16x32_bf16 v[228:231], v[36:39], v[204:207], v[228:231]
  v_mfma_f32_16x16x32_bf16 v[232:235], v[40:43], v[204:207], v[232:235]
  v_mfma_f32_16x16x32_bf16 v[236:239], v[44:47], v[204:207], v[236:239]
  s_waitcnt vmcnt(2) lgkmcnt(0)
  v_mfma_f32_16x16x32_bf16 v[216:219], v[48:51], v[208:211], v[216:219]
  v_mfma_f32_16x16x32_bf16 v[220:223], v[52:55], v[208:211], v[220:223]
  v_mfma_f32_16x16x32_bf16 v[224:227], v[56:59], v[208:211], v[224:227]
  v_mfma_f32_16x16x32_bf16 v[228:231], v[60:63], v[208:211], v[228:231]
  v_mfma_f32_16x16x32_bf16 v[232:235], v[64:67], v[208:211], v[232:235]
  v_mfma_f32_16x16x32_bf16 v[236:239], v[68:71], v[208:211], v[236:239]
  s_waitcnt vmcnt(0) lgkmcnt(0)
  v_mfma_f32_16x16x32_bf16 v[216:219], v[72:75], v[212:215], v[216:219]
  v_mfma_f32_16x16x32_bf16 v[220:223], v[76:79], v[212:215], v[220:223]
  v_mfma_f32_16x16x32_bf16 v[224:227], v[80:83], v[212:215], v[224:227]
  v_mfma_f32_16x16x32_bf16 v[228:231], v[84:87], v[212:215], v[228:231]
  v_mfma_f32_16x16x32_bf16 v[232:235], v[88:91], v[212:215], v[232:235]
  v_mfma_f32_16x16x32_bf16 v[236:239], v[92:95], v[212:215], v[236:239]
  s_add_u32 s51, s51, 1
  s_cmp_gt_u32 s51, 4096
  s_cbranch_scc1 L_s3d_21
  v_cmp_u_f32 vcc, v216, v216
  s_cbranch_vccz L_s3d_21
  v_subrev_u32 v10, 55296, v10
  v_subrev_u32 v11, 55296, v11
  v_subrev_u32 v12, 55296, v12
  v_subrev_u32 v13, 55296, v13
  v_subrev_u32 v14, 55296, v14
  v_subrev_u32 v15, 55296, v15
  v_subrev_u32 v16, 55296, v16
  v_subrev_u32 v17, 55296, v17
  ds_read_b64_tr_b16 v[24:25], v10 offset:0
  ds_read_b64_tr_b16 v[26:27], v12 offset:768
  ds_read_b64_tr_b16 v[28:29], v11 offset:0
  ds_read_b64_tr_b16 v[30:31], v13 offset:768
  ds_read_b64_tr_b16 v[32:33], v10 offset:64
  ds_read_b64_tr_b16 v[34:35], v12 offset:832
  ds_read_b64_tr_b16 v[36:37], v11 offset:64
  ds_read_b64_tr_b16 v[38:39], v13 offset:832
  ds_read_b64_tr_b16 v[40:41], v10 offset:128
  ds_read_b64_tr_b16 v[42:43], v12 offset:896
  ds_read_b64_tr_b16 v[44:45], v11 offset:128
  ds_read_b64_tr_b16 v[46:47], v13 offset:896
  s_waitcnt lgkmcnt(0)
  ds_read_b64_tr_b16 v[48:49], v12 offset:6912
  ds_read_b64_tr_b16 v[50:51], v14 offset:7680
  ds_read_b64_tr_b16 v[52:53], v13 offset:6912
  ds_read_b64_tr_b16 v[54:55], v15 offset:7680
  ds_read_b64_tr_b16 v[56:57], v12 offset:6976
  ds_read_b64_tr_b16 v[58:59], v14 offset:7744
  ds_read_b64_tr_b16 v[60:61], v13 offset:6976
  ds_read_b64_tr_b16 v[62:63], v15 offset:7744
  ds_read_b64_tr_b16 v[64:65], v12 offset:7040
  ds_read_b64_tr_b16 v[66:67], v14 offset:7808
  ds_read_b64_tr_b16 v[68:69], v13 offset:7040
  ds_read_b64_tr_b16 v[70:71], v15 offset:7808
  s_waitcnt lgkmcnt(0)
  ds_read_b64_tr_b16 v[72:73], v14 offset:13824
  ds_read_b64_tr_b16 v[74:75], v16 offset:14592
  ds_read_b64_tr_b16 v[76:77], v15 offset:13824
  ds_read_b64_tr_b16 v[78:79], v17 offset:14592
  ds_read_b64_tr_b16 v[80:81], v14 offset:13888
  ds_read_b64_tr_b16 v[82:83], v16 offset:14656
  ds_read_b64_tr_b16 v[84:85], v15 offset:13888
  ds_read_b64_tr_b16 v[86:87], v17 offset:14656
  ds_read_b64_tr_b16 v[88:89], v14 offset:13952
  ds_read_b64_tr_b16 v[90:91], v16 offset:14720
  ds_read_b64_tr_b16 v[92:93], v15 offset:13952
  ds_read_b64_tr_b16 v[94:95], v17 offset:14720
  s_waitcnt lgkmcnt(0)
  ds_read_b64_tr_b16 v[96:97], v16 offset:20736
  ds_read_b64_tr_b16 v[98:99], v10 offset:21504
  ds_read_b64_tr_b16 v[100:101], v17 offset:20736
  ds_read_b64_tr_b16 v[102:103], v11 offset:21504
  ds_read_b64_tr_b16 v[104:105], v16 offset:20800
  ds_read_b64_tr_b16 v[106:107], v10 offset:21568
  ds_read_b64_tr_b16 v[108:109], v17 offset:20800
  ds_read_b64_tr_b16 v[110:111], v11 offset:21568
  ds_read_b64_tr_b16 v[112:113], v16 offset:20864
  ds_read_b64_tr_b16 v[114:115], v10 offset:21632
  ds_read_b64_tr_b16 v[116:117], v17 offset:20864
  ds_read_b64_tr_b16 v[118:119], v11 offset:21632
  s_waitcnt lgkmcnt(0)
  ds_read_b64_tr_b16 v[120:121], v10 offset:27648
  ds_read_b64_tr_b16 v[122:123], v12 offset:28416
  ds_read_b64_tr_b16 v[124:125], v11 offset:27648
  ds_read_b64_tr_b16 v[126:127], v13 offset:28416
  ds_read_b64_tr_b16 v[128:129], v10 offset:27712
  ds_read_b64_tr_b16 v[130:131], v12 offset:28480
  ds_read_b64_tr_b16 v[132:133], v11 offset:27712
  ds_read_b64_tr_b16 v[134:135], v13 offset:28480
  ds_read_b64_tr_b16 v[136:137], v10 offset:27776
  ds_read_b64_tr_b16 v[138:139], v12 offset:28544
  ds_read_b64_tr_b16 v[140:141], v11 offset:27776
  ds_read_b64_tr_b16 v[142:143], v13 offset:28544
  s_waitcnt lgkmcnt(0)
  s_branch L_s3_20
L_s3d_21:
  s_nop 4
  v_cvt_pk_bf16_f32 v24, v216, v217
  v_cvt_pk_bf16_f32 v25, v218, v219
  v_cvt_pk_bf16_f32 v26, v220, v221
  v_cvt_pk_bf16_f32 v27, v222, v223
  v_cvt_pk_bf16_f32 v28, v224, v225
  v_cvt_pk_bf16_f32 v29, v226, v227
  v_cvt_pk_bf16_f32 v30, v228, v229
  v_cvt_pk_bf16_f32 v31, v230, v231
  v_cvt_pk_bf16_f32 v32, v232, v233
  v_cvt_pk_bf16_f32 v33, v234, v235
  v_cvt_pk_bf16_f32 v34, v236, v237
  v_cvt_pk_bf16_f32 v35, v238, v239
  v_permlane16_swap_b32 v24, v26
  v_permlane16_swap_b32 v25, v27
  buffer_store_dwordx4 v[24:27], v240, s[40:43], s55 offen offset:0
  v_permlane16_swap_b32 v28, v30
  v_permlane16_swap_b32 v29, v31
  buffer_store_dwordx4 v[28:31], v240, s[40:43], s55 offen offset:64
  v_permlane16_swap_b32 v32, v34
  v_permlane16_swap_b32 v33, v35
  buffer_store_dwordx4 v[32:35], v240, s[40:43], s55 offen offset:128
  s_branch L_fin
L_bl:
  s_sub_u32 s54, s3, 24
  s_lshl_b32 s54, s54, 2
  s_add_u32 s54, s54, s44
  s_waitcnt lgkmcnt(0)
  s_mov_b32 s24, s4
  s_and_b32 s25, s5, 0xffff
  s_mov_b32 s26, 2359296
  s_mov_b32 s27, 0x20000
  s_mov_b32 s28, s6
  s_and_b32 s29, s7, 0xffff
  s_mov_b32 s30, 1990656
  s_mov_b32 s31, 0x20000
  s_add_u32 s48, s54, 0
  s_mul_i32 s49, s48, 2850
  s_lshr_b32 s49, s49, 16
  s_mul_i32 s50, s49, 23
  s_sub_u32 s48, s48, s50
  s_add_u32 s49, s49, s59
  s_cmp_ge_u32 s49, 9
  s_cselect_b32 s50, 9, 0
  s_sub_u32 s49, s49, s50
  s_cmp_ge_u32 s48, 8
  s_cbranch_scc1 L_hw_26
  s_and_b32 s50, s45, 3
  s_lshl_b32 s50, s50, 3
  s_add_u32 s50, s50, s48
  s_mul_i32 s50, s50, 73728
  s_lshl_b32 s49, s49, 7
  s_add_u32 s50, s50, s49
  v_mul_u32_u24 v2, 1152, v1
  buffer_load_dword v253, v2, s[24:27], s50 offen
  s_branch L_hd_27
L_hw_26:
  s_sub_u32 s48, s48, 8
  s_mul_i32 s50, s48, 52
  s_lshr_b32 s50, s50, 8
  s_mul_i32 s51, s50, 5
  s_sub_u32 s48, s48, s51
  s_add_u32 s50, s50, 1
  s_cmp_eq_u32 s50, 3
  s_cselect_b32 s50, 0, s50
  s_mul_i32 s50, s50, 1152
  s_lshl_b32 s48, s48, 7
  s_add_u32 s50, s50, s48
  s_lshr_b32 s48, s45, 2
  s_lshl_b32 s48, s48, 9
  s_add_u32 s50, s50, s48
  s_mul_i32 s49, s49, 221184
  s_add_u32 s50, s50, s49
  v_mul_u32_u24 v2, 3456, v1
  buffer_load_dword v253, v2, s[28:31], s50 offen
L_hd_27:
  s_add_u32 s52, s14, 3383296
  s_addc_u32 s53, s15, 0
  s_load_dword s72, s[52:53], 0
  s_mov_b32 s40, s12
  s_and_b32 s41, s13, 0xffff
  s_mov_b32 s42, 2359296
  s_mov_b32 s43, 0x20000
  s_mov_b32 s32, s14
  s_and_b32 s33, s15, 0xffff
  s_mov_b32 s34, 9437184
  s_mov_b32 s35, 0x20000
  s_mov_b32 s36, s10
  s_and_b32 s37, s11, 0xffff
  s_mov_b32 s38, 663552
  s_mov_b32 s39, 0x20000
  s_sub_u32 s67, s3, 24
  s_lshl_b32 s62, s45, 1
  s_and_b32 s48, s67, 1
  s_add_u32 s62, s62, s48
  s_lshr_b32 s63, s67, 1
  s_lshl_b32 s66, s62, 2
  s_add_u32 s66, s66, s44
  s_sub_u32 s49, 27, s54
  s_cmp_ge_u32 s49, (L_end-concat_heads__linear_kernel_hedgehog__spectral_fnet__prompt_kernel+8191)/8192
  s_cbranch_scc1 L_cp_28
  s_getpc_b64 s[50:51]
L_pcref:
  s_lshl_b32 s48, s49, 13
  s_sub_u32 s50, s50, L_pcref-concat_heads__linear_kernel_hedgehog__spectral_fnet__prompt_kernel
  s_subb_u32 s51, s51, 0
  v_lshlrev_b32 v2, 7, v1
  v_add_u32 v2, s48, v2
  v_min_u32 v2, L_end-concat_heads__linear_kernel_hedgehog__spectral_fnet__prompt_kernel, v2
  global_load_dword v253, v2, s[50:51]
L_cp_28:
  s_add_u32 s48, s54, 64
  s_mul_i32 s49, s48, 2850
  s_lshr_b32 s49, s49, 16
  s_mul_i32 s50, s49, 23
  s_sub_u32 s48, s48, s50
  s_add_u32 s49, s49, s59
  s_cmp_ge_u32 s49, 9
  s_cselect_b32 s50, 9, 0
  s_sub_u32 s49, s49, s50
  s_cmp_ge_u32 s48, 8
  s_cbranch_scc1 L_hw_29
  s_and_b32 s50, s45, 3
  s_lshl_b32 s50, s50, 3
  s_add_u32 s50, s50, s48
  s_mul_i32 s50, s50, 73728
  s_lshl_b32 s49, s49, 7
  s_add_u32 s50, s50, s49
  v_mul_u32_u24 v2, 1152, v1
  buffer_load_dword v253, v2, s[24:27], s50 offen
  s_branch L_hd_30
L_hw_29:
  s_sub_u32 s48, s48, 8
  s_mul_i32 s50, s48, 52
  s_lshr_b32 s50, s50, 8
  s_mul_i32 s51, s50, 5
  s_sub_u32 s48, s48, s51
  s_add_u32 s50, s50, 1
  s_cmp_eq_u32 s50, 3
  s_cselect_b32 s50, 0, s50
  s_mul_i32 s50, s50, 1152
  s_lshl_b32 s48, s48, 7
  s_add_u32 s50, s50, s48
  s_lshr_b32 s48, s45, 2
  s_lshl_b32 s48, s48, 9
  s_add_u32 s50, s50, s48
  s_mul_i32 s49, s49, 221184
  s_add_u32 s50, s50, s49
  v_mul_u32_u24 v2, 3456, v1
  buffer_load_dword v253, v2, s[28:31], s50 offen
L_hd_30:
  s_add_u32 s48, s54, 96
  s_mul_i32 s49, s48, 2850
  s_lshr_b32 s49, s49, 16
  s_mul_i32 s50, s49, 23
  s_sub_u32 s48, s48, s50
  s_add_u32 s49, s49, s59
  s_cmp_ge_u32 s49, 9
  s_cselect_b32 s50, 9, 0
  s_sub_u32 s49, s49, s50
  s_cmp_ge_u32 s48, 8
  s_cbranch_scc1 L_hw_31
  s_and_b32 s50, s45, 3
  s_lshl_b32 s50, s50, 3
  s_add_u32 s50, s50, s48
  s_mul_i32 s50, s50, 73728
  s_lshl_b32 s49, s49, 7
  s_add_u32 s50, s50, s49
  v_mul_u32_u24 v2, 1152, v1
  buffer_load_dword v253, v2, s[24:27], s50 offen
  s_branch L_hd_32
L_hw_31:
  s_sub_u32 s48, s48, 8
  s_mul_i32 s50, s48, 52
  s_lshr_b32 s50, s50, 8
  s_mul_i32 s51, s50, 5
  s_sub_u32 s48, s48, s51
  s_add_u32 s50, s50, 1
  s_cmp_eq_u32 s50, 3
  s_cselect_b32 s50, 0, s50
  s_mul_i32 s50, s50, 1152
  s_lshl_b32 s48, s48, 7
  s_add_u32 s50, s50, s48
  s_lshr_b32 s48, s45, 2
  s_lshl_b32 s48, s48, 9
  s_add_u32 s50, s50, s48
  s_mul_i32 s49, s49, 221184
  s_add_u32 s50, s50, s49
  v_mul_u32_u24 v2, 3456, v1
  buffer_load_dword v253, v2, s[28:31], s50 offen
L_hd_32:
  s_add_u32 s48, s54, 128
  s_mul_i32 s49, s48, 2850
  s_lshr_b32 s49, s49, 16
  s_mul_i32 s50, s49, 23
  s_sub_u32 s48, s48, s50
  s_add_u32 s49, s49, s59
  s_cmp_ge_u32 s49, 9
  s_cselect_b32 s50, 9, 0
  s_sub_u32 s49, s49, s50
  s_cmp_ge_u32 s48, 8
  s_cbranch_scc1 L_hw_33
  s_and_b32 s50, s45, 3
  s_lshl_b32 s50, s50, 3
  s_add_u32 s50, s50, s48
  s_mul_i32 s50, s50, 73728
  s_lshl_b32 s49, s49, 7
  s_add_u32 s50, s50, s49
  v_mul_u32_u24 v2, 1152, v1
  buffer_load_dword v253, v2, s[24:27], s50 offen
  s_branch L_hd_34
L_hw_33:
  s_sub_u32 s48, s48, 8
  s_mul_i32 s50, s48, 52
  s_lshr_b32 s50, s50, 8
  s_mul_i32 s51, s50, 5
  s_sub_u32 s48, s48, s51
  s_add_u32 s50, s50, 1
  s_cmp_eq_u32 s50, 3
  s_cselect_b32 s50, 0, s50
  s_mul_i32 s50, s50, 1152
  s_lshl_b32 s48, s48, 7
  s_add_u32 s50, s50, s48
  s_lshr_b32 s48, s45, 2
  s_lshl_b32 s48, s48, 9
  s_add_u32 s50, s50, s48
  s_mul_i32 s49, s49, 221184
  s_add_u32 s50, s50, s49
  v_mul_u32_u24 v2, 3456, v1
  buffer_load_dword v253, v2, s[28:31], s50 offen
L_hd_34:
  v_and_b32 v39, 15, v1
  s_mul_i32 s48, s63, 80
  v_add_u32 v39, s48, v39
  v_lshrrev_b32 v40, 4, v1
  v_lshlrev_b32 v40, 3, v40
  v_add_u32 v40, 288, v40
  v_lshlrev_b32 v41, 4, v1
  s_lshl_b32 s48, s71, 2
  s_add_u32 s48, s48, s44
L_wg_35:
  s_mul_i32 s49, s48, 52
  s_lshr_b32 s49, s49, 8
  s_mul_i32 s50, s49, 5
  s_sub_u32 s50, s48, s50
  s_lshl_b32 s51, s50, 4
  v_add_u32 v15, s51, v39
  s_lshl_b32 s51, s49, 5
  v_add_u32 v36, s51, v40
  v_mul_u32_u24 v37, v15, v36
  v_mul_u32_u24 v38, 7282, v37
  v_lshrrev_b32 v38, 22, v38
  v_mul_u32_u24 v38, 576, v38
  v_sub_u32 v37, v37, v38
  v_cvt_f32_i32 v37, v37
  v_cvt_f32_u32 v15, v15
  v_mul_f32 v37, 0x3ae38e39, v37
  v_mul_f32 v15, 0x3ae38e39, v15
  s_mul_i32 s49, s49, 10240
  s_lshl_b32 s50, s50, 10
  s_add_u32 s49, s49, s50
  v_add_u32 v36, s49, v41
  s_waitcnt lgkmcnt(2)
  v_add_f32 v38, v37, v15
  v_cos_f32 v32, v37
  v_cos_f32 v33, v38
  v_sin_f32 v34, -v37
  v_sin_f32 v35, -v38
  v_cvt_pk_bf16_f32 v16, v32, v33
  v_add_f32 v37, v38, v15
  v_cvt_pk_bf16_f32 v20, v34, v35
  v_add_f32 v38, v37, v15
  v_cos_f32 v32, v37
  v_cos_f32 v33, v38
  v_sin_f32 v34, -v37
  v_sin_f32 v35, -v38
  v_cvt_pk_bf16_f32 v17, v32, v33
  v_add_f32 v37, v38, v15
  v_cvt_pk_bf16_f32 v21, v34, v35
  v_add_f32 v38, v37, v15
  v_cos_f32 v32, v37
  v_cos_f32 v33, v38
  v_sin_f32 v34, -v37
  v_sin_f32 v35, -v38
  v_cvt_pk_bf16_f32 v18, v32, v33
  v_add_f32 v37, v38, v15
  v_cvt_pk_bf16_f32 v22, v34, v35
  v_add_f32 v38, v37, v15
  v_cos_f32 v32, v37
  v_cos_f32 v33, v38
  v_sin_f32 v34, -v37
  v_sin_f32 v35, -v38
  v_cvt_pk_bf16_f32 v19, v32, v33
  v_cvt_pk_bf16_f32 v23, v34, v35
  ds_write_b128 v36, v[16:19] offset:0
  ds_write_b128 v36, v[20:23] offset:5120
  s_add_u32 s48, s48, 8
  s_cmp_lt_u32 s48, 45
  s_cbranch_scc0 L_wgd_36
  s_mul_i32 s49, s48, 52
  s_lshr_b32 s49, s49, 8
  s_mul_i32 s50, s49, 5
  s_sub_u32 s50, s48, s50
  s_lshl_b32 s51, s50, 4
  v_add_u32 v15, s51, v39
  s_lshl_b32 s51, s49, 5
  v_add_u32 v36, s51, v40
  v_mul_u32_u24 v37, v15, v36
  v_mul_u32_u24 v38, 7282, v37
  v_lshrrev_b32 v38, 22, v38
  v_mul_u32_u24 v38, 576, v38
  v_sub_u32 v37, v37, v38
  v_cvt_f32_i32 v37, v37
  v_cvt_f32_u32 v15, v15
  v_mul_f32 v37, 0x3ae38e39, v37
  v_mul_f32 v15, 0x3ae38e39, v15
  s_mul_i32 s49, s49, 10240
  s_lshl_b32 s50, s50, 10
  s_add_u32 s49, s49, s50
  v_add_u32 v36, s49, v41
  s_waitcnt lgkmcnt(2)
  v_add_f32 v38, v37, v15
  v_cos_f32 v32, v37
  v_cos_f32 v33, v38
  v_sin_f32 v34, -v37
  v_sin_f32 v35, -v38
  v_cvt_pk_bf16_f32 v24, v32, v33
  v_add_f32 v37, v38, v15
  v_cvt_pk_bf16_f32 v28, v34, v35
  v_add_f32 v38, v37, v15
  v_cos_f32 v32, v37
  v_cos_f32 v33, v38
  v_sin_f32 v34, -v37
  v_sin_f32 v35, -v38
  v_cvt_pk_bf16_f32 v25, v32, v33
  v_add_f32 v37, v38, v15
  v_cvt_pk_bf16_f32 v29, v34, v35
  v_add_f32 v38, v37, v15
  v_cos_f32 v32, v37
  v_cos_f32 v33, v38
  v_sin_f32 v34, -v37
  v_sin_f32 v35, -v38
  v_cvt_pk_bf16_f32 v26, v32, v33
  v_add_f32 v37, v38, v15
  v_cvt_pk_bf16_f32 v30, v34, v35
  v_add_f32 v38, v37, v15
  v_cos_f32 v32, v37
  v_cos_f32 v33, v38
  v_sin_f32 v34, -v37
  v_sin_f32 v35, -v38
  v_cvt_pk_bf16_f32 v27, v32, v33
  v_cvt_pk_bf16_f32 v31, v34, v35
  ds_write_b128 v36, v[24:27] offset:0
  ds_write_b128 v36, v[28:31] offset:5120
  s_add_u32 s48, s48, 8
  s_cmp_lt_u32 s48, 45
  s_cbranch_scc1 L_wg_35
L_wgd_36:
  s_waitcnt lgkmcnt(0)
  v_mul_u32_u24 v2, 73728, v5
  v_and_b32 v3, 7, v1
  v_mul_u32_u24 v3, 1152, v3
  v_add_u32 v3, v2, v3
  s_lshr_b32 s48, s54, 2
  s_lshl_b32 s48, s48, 7
  s_mul_i32 s49, s44, 589824
  s_add_u32 s48, s48, s49
  s_mul_i32 s49, s45, 9216
  s_add_u32 s48, s48, s49
  buffer_load_dword v253, v3, s[40:43], s48 offen
  s_cmp_ge_u32 s54, 28
  s_cselect_b32 s49, 128, 1073741824
  s_add_u32 s48, s48, s49
  buffer_load_dword v253, v3, s[40:43], s48 offen
  v_mul_u32_u24 v2, 73728, v5
  v_add_u32 v7, v2, v14
  v_xor_b32 v8, 64, v7
  s_mul_i32 s56, s66, 1152
  s_waitcnt lgkmcnt(0)
  s_add_u32 s72, s72, 1
  s_add_u32 s60, s56, 0
  s_add_u32 m0, s64, 92160
  s_nop 0
  buffer_load_dwordx4 v7, s[40:43], s60 offen lds
  s_add_u32 s60, s56, 589824
  s_add_u32 m0, s64, 93184
  s_nop 0
  buffer_load_dwordx4 v8, s[40:43], s60 offen lds
  s_add_u32 s60, s56, 1179648
  s_add_u32 m0, s64, 94208
  s_nop 0
  buffer_load_dwordx4 v7, s[40:43], s60 offen lds
  s_add_u32 s60, s56, 1769472
  s_add_u32 m0, s64, 95232
  s_nop 0
  buffer_load_dwordx4 v8, s[40:43], s60 offen lds
  s_add_u32 s60, s56, 128
  s_add_u32 m0, s64, 108544
  s_nop 0
  buffer_load_dwordx4 v7, s[40:43], s60 offen lds
  s_add_u32 s60, s56, 589952
  s_add_u32 m0, s64, 109568
  s_nop 0
  buffer_load_dwordx4 v8, s[40:43], s60 offen lds
  s_add_u32 s60, s56, 1179776
  s_add_u32 m0, s64, 110592
  s_nop 0
  buffer_load_dwordx4 v7, s[40:43], s60 offen lds
  s_add_u32 s60, s56, 1769600
  s_add_u32 m0, s64, 111616
  s_nop 0
  buffer_load_dwordx4 v8, s[40:43], s60 offen lds
  s_add_u32 s60, s56, 256
  s_add_u32 m0, s64, 124928
  s_nop 0
  buffer_load_dwordx4 v7, s[40:43], s60 offen lds
  s_add_u32 s60, s56, 590080
  s_add_u32 m0, s64, 125952
  s_nop 0
  buffer_load_dwordx4 v8, s[40:43], s60 offen lds
  s_add_u32 s60, s56, 1179904
  s_add_u32 m0, s64, 126976
  s_nop 0
  buffer_load_dwordx4 v7, s[40:43], s60 offen lds
  s_add_u32 s60, s56, 1769728
  s_add_u32 m0, s64, 128000
  s_nop 0
  buffer_load_dwordx4 v8, s[40:43], s60 offen lds
  s_add_u32 s48, s54, 160
  s_mul_i32 s49, s48, 2850
  s_lshr_b32 s49, s49, 16
  s_mul_i32 s50, s49, 23
  s_sub_u32 s48, s48, s50
  s_add_u32 s49, s49, s59
  s_cmp_ge_u32 s49, 9
  s_cselect_b32 s50, 9, 0
  s_sub_u32 s49, s49, s50
  s_cmp_ge_u32 s48, 8
  s_cbranch_scc1 L_hw_37
  s_and_b32 s50, s45, 3
  s_lshl_b32 s50, s50, 3
  s_add_u32 s50, s50, s48
  s_mul_i32 s50, s50, 73728
  s_lshl_b32 s49, s49, 7
  s_add_u32 s50, s50, s49
  v_mul_u32_u24 v2, 1152, v1
  buffer_load_dword v253, v2, s[24:27], s50 offen
  s_branch L_hd_38
L_hw_37:
  s_sub_u32 s48, s48, 8
  s_mul_i32 s50, s48, 52
  s_lshr_b32 s50, s50, 8
  s_mul_i32 s51, s50, 5
  s_sub_u32 s48, s48, s51
  s_add_u32 s50, s50, 1
  s_cmp_eq_u32 s50, 3
  s_cselect_b32 s50, 0, s50
  s_mul_i32 s50, s50, 1152
  s_lshl_b32 s48, s48, 7
  s_add_u32 s50, s50, s48
  s_lshr_b32 s48, s45, 2
  s_lshl_b32 s48, s48, 9
  s_add_u32 s50, s50, s48
  s_mul_i32 s49, s49, 221184
  s_add_u32 s50, s50, s49
  v_mul_u32_u24 v2, 3456, v1
  buffer_load_dword v253, v2, s[28:31], s50 offen
L_hd_38:
  s_waitcnt vmcnt(9)
  s_barrier
  s_waitcnt vmcnt(5)
  s_barrier
  s_add_u32 s60, s56, 384
  s_add_u32 m0, s64, 92160
  s_nop 0
  buffer_load_dwordx4 v7, s[40:43], s60 offen lds
  s_add_u32 s60, s56, 590208
  s_add_u32 m0, s64, 93184
  s_nop 0
  buffer_load_dwordx4 v8, s[40:43], s60 offen lds
  s_add_u32 s60, s56, 1180032
  s_add_u32 m0, s64, 94208
  s_nop 0
  buffer_load_dwordx4 v7, s[40:43], s60 offen lds
  s_add_u32 s60, s56, 1769856
  s_add_u32 m0, s64, 95232
  s_nop 0
  buffer_load_dwordx4 v8, s[40:43], s60 offen lds
  s_add_u32 s48, s54, 192
  s_mul_i32 s49, s48, 2850
  s_lshr_b32 s49, s49, 16
  s_mul_i32 s50, s49, 23
  s_sub_u32 s48, s48, s50
  s_cmp_ge_u32 s49, 9
  s_cbranch_scc1 L_hd_40
  s_add_u32 s49, s49, s59
  s_cmp_ge_u32 s49, 9
  s_cselect_b32 s50, 9, 0
  s_sub_u32 s49, s49, s50
  s_cmp_ge_u32 s48, 8
  s_cbranch_scc1 L_hw_39
  s_and_b32 s50, s45, 3
  s_lshl_b32 s50, s50, 3
  s_add_u32 s50, s50, s48
  s_mul_i32 s50, s50, 73728
  s_lshl_b32 s49, s49, 7
  s_add_u32 s50, s50, s49
  v_mul_u32_u24 v2, 1152, v1
  buffer_load_dword v253, v2, s[24:27], s50 offen
  s_branch L_hd_40
L_hw_39:
  s_sub_u32 s48, s48, 8
  s_mul_i32 s50, s48, 52
  s_lshr_b32 s50, s50, 8
  s_mul_i32 s51, s50, 5
  s_sub_u32 s48, s48, s51
  s_add_u32 s50, s50, 1
  s_cmp_eq_u32 s50, 3
  s_cselect_b32 s50, 0, s50
  s_mul_i32 s50, s50, 1152
  s_lshl_b32 s48, s48, 7
  s_add_u32 s50, s50, s48
  s_lshr_b32 s48, s45, 2
  s_lshl_b32 s48, s48, 9
  s_add_u32 s50, s50, s48
  s_mul_i32 s49, s49, 221184
  s_add_u32 s50, s50, s49
  v_mul_u32_u24 v2, 3456, v1
  buffer_load_dword v253, v2, s[28:31], s50 offen
L_hd_40:
  s_waitcnt vmcnt(5)
  s_barrier
  s_add_u32 s60, s56, 512
  s_add_u32 m0, s64, 108544
  s_nop 0
  buffer_load_dwordx4 v7, s[40:43], s60 offen lds
  s_add_u32 s60, s56, 590336
  s_add_u32 m0, s64, 109568
  s_nop 0
  buffer_load_dwordx4 v8, s[40:43], s60 offen lds
  s_add_u32 s60, s56, 1180160
  s_add_u32 m0, s64, 110592
  s_nop 0
  buffer_load_dwordx4 v7, s[40:43], s60 offen lds
  s_add_u32 s60, s56, 1769984
  s_add_u32 m0, s64, 111616
  s_nop 0
  buffer_load_dwordx4 v8, s[40:43], s60 offen lds
  s_mul_i32 s49, s45, 10
  s_add_u32 s48, s54, 0
  s_add_u32 s49, s49, s48
  s_cmp_ge_u32 s49, 81
  s_cselect_b32 s50, 81, 0
  s_sub_u32 s49, s49, s50
  s_lshl_b32 s49, s49, 13
  s_cmp_lt_u32 s48, 81
  s_cselect_b32 s49, s49, 1073741824
  v_lshlrev_b32 v2, 7, v1
  buffer_load_dword v253, v2, s[36:39], s49 offen
  s_waitcnt vmcnt(5)
  s_barrier
  s_add_u32 s60, s56, 640
  s_add_u32 m0, s64, 124928
  s_nop 0
  buffer_load_dwordx4 v7, s[40:43], s60 offen lds
  s_add_u32 s60, s56, 590464
  s_add_u32 m0, s64, 125952
  s_nop 0
  buffer_load_dwordx4 v8, s[40:43], s60 offen lds
  s_add_u32 s60, s56, 1180288
  s_add_u32 m0, s64, 126976
  s_nop 0
  buffer_load_dwordx4 v7, s[40:43], s60 offen lds
  s_add_u32 s60, s56, 1770112
  s_add_u32 m0, s64, 128000
  s_nop 0
  buffer_load_dwordx4 v8, s[40:43], s60 offen lds
  s_mul_i32 s49, s45, 10
  s_add_u32 s48, s54, 32
  s_add_u32 s49, s49, s48
  s_cmp_ge_u32 s49, 81
  s_cselect_b32 s50, 81, 0
  s_sub_u32 s49, s49, s50
  s_lshl_b32 s49, s49, 13
  s_cmp_lt_u32 s48, 81
  s_cselect_b32 s49, s49, 1073741824
  v_lshlrev_b32 v2, 7, v1
  buffer_load_dword v253, v2, s[36:39], s49 offen
  s_waitcnt vmcnt(6)
  s_barrier
  s_add_u32 s60, s56, 768
  s_add_u32 m0, s64, 92160
  s_nop 0
  buffer_load_dwordx4 v7, s[40:43], s60 offen lds
  s_add_u32 s60, s56, 590592
  s_add_u32 m0, s64, 93184
  s_nop 0
  buffer_load_dwordx4 v8, s[40:43], s60 offen lds
  s_add_u32 s60, s56, 1180416
  s_add_u32 m0, s64, 94208
  s_nop 0
  buffer_load_dwordx4 v7, s[40:43], s60 offen lds
  s_add_u32 s60, s56, 1770240
  s_add_u32 m0, s64, 95232
  s_nop 0
  buffer_load_dwordx4 v8, s[40:43], s60 offen lds
  s_mul_i32 s49, s45, 10
  s_add_u32 s48, s54, 64
  s_add_u32 s49, s49, s48
  s_cmp_ge_u32 s49, 81
  s_cselect_b32 s50, 81, 0
  s_sub_u32 s49, s49, s50
  s_lshl_b32 s49, s49, 13
  s_cmp_lt_u32 s48, 81
  s_cselect_b32 s49, s49, 1073741824
  v_lshlrev_b32 v2, 7, v1
  buffer_load_dword v253, v2, s[36:39], s49 offen
  s_waitcnt vmcnt(6)
  s_barrier
  s_add_u32 s60, s56, 896
  s_add_u32 m0, s64, 108544
  s_nop 0
  buffer_load_dwordx4 v7, s[40:43], s60 offen lds
  s_add_u32 s60, s56, 590720
  s_add_u32 m0, s64, 109568
  s_nop 0
  buffer_load_dwordx4 v8, s[40:43], s60 offen lds
  s_add_u32 s60, s56, 1180544
  s_add_u32 m0, s64, 110592
  s_nop 0
  buffer_load_dwordx4 v7, s[40:43], s60 offen lds
  s_add_u32 s60, s56, 1770368
  s_add_u32 m0, s64, 111616
  s_nop 0
  buffer_load_dwordx4 v8, s[40:43], s60 offen lds
  s_waitcnt vmcnt(5)
  s_barrier
  s_add_u32 s60, s56, 1024
  s_add_u32 m0, s64, 124928
  s_nop 0
  buffer_load_dwordx4 v7, s[40:43], s60 offen lds
  s_add_u32 s60, s56, 590848
  s_add_u32 m0, s64, 125952
  s_nop 0
  buffer_load_dwordx4 v8, s[40:43], s60 offen lds
  s_add_u32 s60, s56, 1180672
  s_add_u32 m0, s64, 126976
  s_nop 0
  buffer_load_dwordx4 v7, s[40:43], s60 offen lds
  s_add_u32 s60, s56, 1770496
  s_add_u32 m0, s64, 128000
  s_nop 0
  buffer_load_dwordx4 v8, s[40:43], s60 offen lds
  s_waitcnt vmcnt(4)
  s_barrier
  s_waitcnt vmcnt(0)
  s_barrier
  v_add_u32 v3, 0, v0
  v_mul_u32_u24 v4, 1639, v3
  v_lshrrev_b32 v4, 17, v4
  v_mul_u32_u24 v4, 5040, v4
  v_add_lshl_u32 v15, v4, v3, 4
  v_add_u32 v3, 512, v0
  v_mul_u32_u24 v4, 1639, v3
  v_lshrrev_b32 v4, 17, v4
  v_mul_u32_u24 v4, 5040, v4
  v_add_lshl_u32 v36, v4, v3, 4
  v_add_u32 v3, 1024, v0
  v_mul_u32_u24 v4, 1639, v3
  v_lshrrev_b32 v4, 17, v4
  v_mul_u32_u24 v4, 5040, v4
  v_add_lshl_u32 v37, v4, v3, 4
  v_add_u32 v3, 1536, v0
  v_mul_u32_u24 v4, 1639, v3
  v_lshrrev_b32 v4, 17, v4
  v_mul_u32_u24 v4, 5040, v4
  v_add_lshl_u32 v38, v4, v3, 4
  v_add_u32 v3, 2048, v0
  v_mul_u32_u24 v4, 1639, v3
  v_lshrrev_b32 v4, 17, v4
  v_mul_u32_u24 v4, 5040, v4
  v_add_lshl_u32 v39, v4, v3, 4
  v_lshlrev_b32 v40, 2, v0
  v_add_u32 v40, 0, v40
  s_mul_i32 s55, s62, 320
  s_mul_i32 s49, s63, 80
  s_add_u32 s55, s55, s49
  s_lshl_b32 s55, s55, 4
  s_add_u32 s55, s55, 6815744
  s_barrier
  s_lshl_b32 s48, s2, 2
  s_add_u32 s48, s48, s44
  s_cmp_lg_u32 s48, 768
  s_cbranch_scc1 L_ep_41
  v_and_b32 v2, 15, v1
  v_lshlrev_b32 v2, 7, v2
  v_lshrrev_b32 v3, 4, v1
  v_lshl_add_u32 v2, v3, 13, v2
  s_mov_b32 s68, 0
L_epl_42:
  s_mov_b32 s48, 3252224
  buffer_load_dword v44, v2, s[32:35], s48 offen sc1
  s_mov_b32 s48, 3284992
  buffer_load_dword v45, v2, s[32:35], s48 offen sc1
  s_mov_b32 s48, 3317760
  buffer_load_dword v46, v2, s[32:35], s48 offen sc1
  s_mov_b32 s48, 3350528
  buffer_load_dword v47, v2, s[32:35], s48 offen sc1
  s_add_u32 s68, s68, 1
  s_waitcnt vmcnt(0)
  v_xor_b32 v44, s72, v44
  v_xor_b32 v45, s72, v45
  v_xor_b32 v46, s72, v46
  v_xor_b32 v47, s72, v47
  v_or3_b32 v44, v44, v45, v46
  v_or_b32 v44, v44, v47
  v_cmp_ne_u32 vcc, 0, v44
  s_cmp_gt_u32 s68, 65536
  s_cbranch_scc1 L_ep_41
  s_cbranch_vccnz L_epl_42
L_ep_41:
  s_barrier
  ds_read2st64_b32 v[16:17], v40 offset0:0 offset1:40
  ds_read2st64_b32 v[18:19], v40 offset0:80 offset1:120
  ds_read2st64_b32 v[20:21], v40 offset0:8 offset1:48
  ds_read2st64_b32 v[22:23], v40 offset0:88 offset1:128
  ds_read2st64_b32 v[24:25], v40 offset0:16 offset1:56
  ds_read2st64_b32 v[26:27], v40 offset0:96 offset1:136
  ds_read2st64_b32 v[28:29], v40 offset0:24 offset1:64
  ds_read2st64_b32 v[30:31], v40 offset0:104 offset1:144
  ds_read2st64_b32 v[32:33], v40 offset0:32 offset1:72
  ds_read2st64_b32 v[34:35], v40 offset0:112 offset1:152
  s_waitcnt lgkmcnt(8)
  buffer_store_dwordx4 v[16:19], v15, s[32:35], s55 offen sc1
  s_waitcnt lgkmcnt(6)
  buffer_store_dwordx4 v[20:23], v36, s[32:35], s55 offen sc1
  s_waitcnt lgkmcnt(4)
  buffer_store_dwordx4 v[24:27], v37, s[32:35], s55 offen sc1
  s_waitcnt lgkmcnt(2)
  buffer_store_dwordx4 v[28:31], v38, s[32:35], s55 offen sc1
  s_waitcnt lgkmcnt(0)
  buffer_store_dwordx4 v[32:35], v39, s[32:35], s55 offen sc1
  s_waitcnt vmcnt(0)
  s_barrier
  s_cmp_lg_u32 s44, 0
  s_cbranch_scc1 L_fin
  s_lshl_b32 s48, s62, 2
  s_add_u32 s48, s48, s63
  s_lshl_b32 s48, s48, 7
  s_add_u32 s48, s48, 3178496
  s_mov_b64 exec, 1
  v_mov_b32 v255, s72
  v_mov_b32 v254, 0
  buffer_store_dword v255, v254, s[32:35], s48 offen sc1
  s_mov_b64 exec, -1
  v_lshlrev_b32 v2, 7, v1
  s_mov_b32 s48, 3178496
  s_mov_b32 s68, 0
L_poll_43:
  buffer_load_dword v4, v2, s[32:35], s48 offen sc1
  s_add_u32 s68, s68, 1
  s_cmp_gt_u32 s68, 65536
  s_cbranch_scc1 L_pdone_44
  s_waitcnt vmcnt(0)
  v_cmp_ne_u32 vcc, s72, v4
  s_cbranch_vccnz L_poll_43
L_pdone_44:
  s_waitcnt vmcnt(0)
  s_barrier
  s_cmp_lg_u32 s2, 192
  s_cbranch_scc1 L_fin
  s_mov_b32 s48, 3383296
  s_mov_b64 exec, 1
  v_mov_b32 v255, s72
  v_mov_b32 v254, 0
  buffer_store_dword v255, v254, s[32:35], s48 offen sc1
  s_mov_b64 exec, -1
  s_branch L_fin
L_bc:
  s_sub_u32 s67, s3, 24
  s_lshl_b32 s62, s45, 1
  s_and_b32 s48, s67, 1
  s_add_u32 s62, s62, s48
  s_lshr_b32 s63, s67, 1
  s_lshl_b32 s66, s62, 2
  s_add_u32 s66, s66, s44
  v_and_b32 v37, 15, v1
  s_mul_i32 s48, s63, 80
  v_add_u32 v37, s48, v37
  v_lshrrev_b32 v38, 4, v1
  v_lshlrev_b32 v38, 3, v38
  v_add_u32 v38, 288, v38
  v_lshlrev_b32 v39, 4, v1
  s_lshl_b32 s48, s71, 2
  s_add_u32 s48, s48, s44
L_wg_45:
  s_mul_i32 s49, s48, 52
  s_lshr_b32 s49, s49, 8
  s_mul_i32 s50, s49, 5
  s_sub_u32 s50, s48, s50
  s_lshl_b32 s51, s50, 4
  v_add_u32 v13, s51, v37
  s_lshl_b32 s51, s49, 5
  v_add_u32 v14, s51, v38
  v_mul_u32_u24 v15, v13, v14
  v_mul_u32_u24 v36, 7282, v15
  v_lshrrev_b32 v36, 22, v36
  v_mul_u32_u24 v36, 576, v36
  v_sub_u32 v15, v15, v36
  v_cvt_f32_i32 v15, v15
  v_cvt_f32_u32 v13, v13
  v_mul_f32 v15, 0x3ae38e39, v15
  v_mul_f32 v13, 0x3ae38e39, v13
  s_mul_i32 s49, s49, 10240
  s_lshl_b32 s50, s50, 10
  s_add_u32 s49, s49, s50
  v_add_u32 v14, s49, v39
  s_waitcnt lgkmcnt(2)
  v_add_f32 v36, v15, v13
  v_cos_f32 v32, v15
  v_cos_f32 v33, v36
  v_sin_f32 v34, -v15
  v_sin_f32 v35, -v36
  v_cvt_pk_bf16_f32 v16, v32, v33
  v_add_f32 v15, v36, v13
  v_cvt_pk_bf16_f32 v20, v34, v35
  v_add_f32 v36, v15, v13
  v_cos_f32 v32, v15
  v_cos_f32 v33, v36
  v_sin_f32 v34, -v15
  v_sin_f32 v35, -v36
  v_cvt_pk_bf16_f32 v17, v32, v33
  v_add_f32 v15, v36, v13
  v_cvt_pk_bf16_f32 v21, v34, v35
  v_add_f32 v36, v15, v13
  v_cos_f32 v32, v15
  v_cos_f32 v33, v36
  v_sin_f32 v34, -v15
  v_sin_f32 v35, -v36
  v_cvt_pk_bf16_f32 v18, v32, v33
  v_add_f32 v15, v36, v13
  v_cvt_pk_bf16_f32 v22, v34, v35
  v_add_f32 v36, v15, v13
  v_cos_f32 v32, v15
  v_cos_f32 v33, v36
  v_sin_f32 v34, -v15
  v_sin_f32 v35, -v36
  v_cvt_pk_bf16_f32 v19, v32, v33
  v_cvt_pk_bf16_f32 v23, v34, v35
  ds_write_b128 v14, v[16:19] offset:0
  ds_write_b128 v14, v[20:23] offset:5120
  s_add_u32 s48, s48, 8
  s_cmp_lt_u32 s48, 45
  s_cbranch_scc0 L_wgd_46
  s_mul_i32 s49, s48, 52
  s_lshr_b32 s49, s49, 8
  s_mul_i32 s50, s49, 5
  s_sub_u32 s50, s48, s50
  s_lshl_b32 s51, s50, 4
  v_add_u32 v13, s51, v37
  s_lshl_b32 s51, s49, 5
  v_add_u32 v14, s51, v38
  v_mul_u32_u24 v15, v13, v14
  v_mul_u32_u24 v36, 7282, v15
  v_lshrrev_b32 v36, 22, v36
  v_mul_u32_u24 v36, 576, v36
  v_sub_u32 v15, v15, v36
  v_cvt_f32_i32 v15, v15
  v_cvt_f32_u32 v13, v13
  v_mul_f32 v15, 0x3ae38e39, v15
  v_mul_f32 v13, 0x3ae38e39, v13
  s_mul_i32 s49, s49, 10240
  s_lshl_b32 s50, s50, 10
  s_add_u32 s49, s49, s50
  v_add_u32 v14, s49, v39
  s_waitcnt lgkmcnt(2)
  v_add_f32 v36, v15, v13
  v_cos_f32 v32, v15
  v_cos_f32 v33, v36
  v_sin_f32 v34, -v15
  v_sin_f32 v35, -v36
  v_cvt_pk_bf16_f32 v24, v32, v33
  v_add_f32 v15, v36, v13
  v_cvt_pk_bf16_f32 v28, v34, v35
  v_add_f32 v36, v15, v13
  v_cos_f32 v32, v15
  v_cos_f32 v33, v36
  v_sin_f32 v34, -v15
  v_sin_f32 v35, -v36
  v_cvt_pk_bf16_f32 v25, v32, v33
  v_add_f32 v15, v36, v13
  v_cvt_pk_bf16_f32 v29, v34, v35
  v_add_f32 v36, v15, v13
  v_cos_f32 v32, v15
  v_cos_f32 v33, v36
  v_sin_f32 v34, -v15
  v_sin_f32 v35, -v36
  v_cvt_pk_bf16_f32 v26, v32, v33
  v_add_f32 v15, v36, v13
  v_cvt_pk_bf16_f32 v30, v34, v35
  v_add_f32 v36, v15, v13
  v_cos_f32 v32, v15
  v_cos_f32 v33, v36
  v_sin_f32 v34, -v15
  v_sin_f32 v35, -v36
  v_cvt_pk_bf16_f32 v27, v32, v33
  v_cvt_pk_bf16_f32 v31, v34, v35
  ds_write_b128 v14, v[24:27] offset:0
  ds_write_b128 v14, v[28:31] offset:5120
  s_add_u32 s48, s48, 8
  s_cmp_lt_u32 s48, 45
  s_cbranch_scc1 L_wg_45
L_wgd_46:
  s_waitcnt lgkmcnt(0)
  s_mov_b32 s32, s14
  s_and_b32 s33, s15, 0xffff
  s_mov_b32 s34, 9437184
  s_mov_b32 s35, 0x20000
  s_mov_b32 s40, s20
  s_and_b32 s41, s21, 0xffff
  s_mov_b32 s42, 4718592
  s_mov_b32 s43, 0x20000
  v_and_b32 v2, 15, v1
  v_lshrrev_b32 v3, 4, v1
  v_lshlrev_b32 v3, 8, v3
  v_add_u32 v3, s66, v3
  v_add_u32 v4, 0, v3
  v_mul_u32_u24 v4, v4, v2
  v_and_b32 v4, 2047, v4
  v_cvt_f32_u32 v4, v4
  v_mul_f32 v4, 0x3a000000, v4
  v_cos_f32 v9, v4
  v_sin_f32 v10, v4
  v_add_u32 v4, 64, v3
  v_mul_u32_u24 v4, v4, v2
  v_and_b32 v4, 2047, v4
  v_cvt_f32_u32 v4, v4
  v_mul_f32 v4, 0x3a000000, v4
  v_cos_f32 v11, v4
  v_sin_f32 v12, v4
  v_cvt_pk_bf16_f32 v20, v9, v11
  v_cvt_pk_bf16_f32 v28, v10, v12
  v_xor_b32 v36, 0x80008000, v28
  v_add_u32 v4, 128, v3
  v_mul_u32_u24 v4, v4, v2
  v_and_b32 v4, 2047, v4
  v_cvt_f32_u32 v4, v4
  v_mul_f32 v4, 0x3a000000, v4
  v_cos_f32 v9, v4
  v_sin_f32 v10, v4
  v_add_u32 v4, 192, v3
  v_mul_u32_u24 v4, v4, v2
  v_and_b32 v4, 2047, v4
  v_cvt_f32_u32 v4, v4
  v_mul_f32 v4, 0x3a000000, v4
  v_cos_f32 v11, v4
  v_sin_f32 v12, v4
  v_cvt_pk_bf16_f32 v21, v9, v11
  v_cvt_pk_bf16_f32 v29, v10, v12
  v_xor_b32 v37, 0x80008000, v29
  v_add_u32 v4, 1024, v3
  v_mul_u32_u24 v4, v4, v2
  v_and_b32 v4, 2047, v4
  v_cvt_f32_u32 v4, v4
  v_mul_f32 v4, 0x3a000000, v4
  v_cos_f32 v9, v4
  v_sin_f32 v10, v4
  v_add_u32 v4, 1088, v3
  v_mul_u32_u24 v4, v4, v2
  v_and_b32 v4, 2047, v4
  v_cvt_f32_u32 v4, v4
  v_mul_f32 v4, 0x3a000000, v4
  v_cos_f32 v11, v4
  v_sin_f32 v12, v4
  v_cvt_pk_bf16_f32 v22, v9, v11
  v_cvt_pk_bf16_f32 v30, v10, v12
  v_xor_b32 v38, 0x80008000, v30
  v_add_u32 v4, 1152, v3
  v_mul_u32_u24 v4, v4, v2
  v_and_b32 v4, 2047, v4
  v_cvt_f32_u32 v4, v4
  v_mul_f32 v4, 0x3a000000, v4
  v_cos_f32 v9, v4
  v_sin_f32 v10, v4
  v_add_u32 v4, 1216, v3
  v_mul_u32_u24 v4, v4, v2
  v_and_b32 v4, 2047, v4
  v_cvt_f32_u32 v4, v4
  v_mul_f32 v4, 0x3a000000, v4
  v_cos_f32 v11, v4
  v_sin_f32 v12, v4
  v_cvt_pk_bf16_f32 v23, v9, v11
  v_cvt_pk_bf16_f32 v31, v10, v12
  v_xor_b32 v39, 0x80008000, v31
  v_add_u32 v2, 16, v2
  v_add_u32 v4, 0, v3
  v_mul_u32_u24 v4, v4, v2
  v_and_b32 v4, 2047, v4
  v_cvt_f32_u32 v4, v4
  v_mul_f32 v4, 0x3a000000, v4
  v_cos_f32 v9, v4
  v_sin_f32 v10, v4
  v_add_u32 v4, 64, v3
  v_mul_u32_u24 v4, v4, v2
  v_and_b32 v4, 2047, v4
  v_cvt_f32_u32 v4, v4
  v_mul_f32 v4, 0x3a000000, v4
  v_cos_f32 v11, v4
  v_sin_f32 v12, v4
  v_cvt_pk_bf16_f32 v24, v9, v11
  v_cvt_pk_bf16_f32 v32, v10, v12
  v_xor_b32 v40, 0x80008000, v32
  v_add_u32 v4, 128, v3
  v_mul_u32_u24 v4, v4, v2
  v_and_b32 v4, 2047, v4
  v_cvt_f32_u32 v4, v4
  v_mul_f32 v4, 0x3a000000, v4
  v_cos_f32 v9, v4
  v_sin_f32 v10, v4
  v_add_u32 v4, 192, v3
  v_mul_u32_u24 v4, v4, v2
  v_and_b32 v4, 2047, v4
  v_cvt_f32_u32 v4, v4
  v_mul_f32 v4, 0x3a000000, v4
  v_cos_f32 v11, v4
  v_sin_f32 v12, v4
  v_cvt_pk_bf16_f32 v25, v9, v11
  v_cvt_pk_bf16_f32 v33, v10, v12
  v_xor_b32 v41, 0x80008000, v33
  v_add_u32 v4, 1024, v3
  v_mul_u32_u24 v4, v4, v2
  v_and_b32 v4, 2047, v4
  v_cvt_f32_u32 v4, v4
  v_mul_f32 v4, 0x3a000000, v4
  v_cos_f32 v9, v4
  v_sin_f32 v10, v4
  v_add_u32 v4, 1088, v3
  v_mul_u32_u24 v4, v4, v2
  v_and_b32 v4, 2047, v4
  v_cvt_f32_u32 v4, v4
  v_mul_f32 v4, 0x3a000000, v4
  v_cos_f32 v11, v4
  v_sin_f32 v12, v4
  v_cvt_pk_bf16_f32 v26, v9, v11
  v_cvt_pk_bf16_f32 v34, v10, v12
  v_xor_b32 v42, 0x80008000, v34
  v_add_u32 v4, 1152, v3
  v_mul_u32_u24 v4, v4, v2
  v_and_b32 v4, 2047, v4
  v_cvt_f32_u32 v4, v4
  v_mul_f32 v4, 0x3a000000, v4
  v_cos_f32 v9, v4
  v_sin_f32 v10, v4
  v_add_u32 v4, 1216, v3
  v_mul_u32_u24 v4, v4, v2
  v_and_b32 v4, 2047, v4
  v_cvt_f32_u32 v4, v4
  v_mul_f32 v4, 0x3a000000, v4
  v_cos_f32 v11, v4
  v_sin_f32 v12, v4
  v_cvt_pk_bf16_f32 v27, v9, v11
  v_cvt_pk_bf16_f32 v35, v10, v12
  v_xor_b32 v43, 0x80008000, v35
  v_add_u32 v3, 0, v0
  v_mul_u32_u24 v4, 1639, v3
  v_lshrrev_b32 v4, 17, v4
  v_mul_u32_u24 v4, 5040, v4
  v_add_lshl_u32 v17, v4, v3, 4
  v_add_u32 v3, 512, v0
  v_mul_u32_u24 v4, 1639, v3
  v_lshrrev_b32 v4, 17, v4
  v_mul_u32_u24 v4, 5040, v4
  v_add_lshl_u32 v124, v4, v3, 4
  v_add_u32 v3, 1024, v0
  v_mul_u32_u24 v4, 1639, v3
  v_lshrrev_b32 v4, 17, v4
  v_mul_u32_u24 v4, 5040, v4
  v_add_lshl_u32 v125, v4, v3, 4
  v_add_u32 v3, 1536, v0
  v_mul_u32_u24 v4, 1639, v3
  v_lshrrev_b32 v4, 17, v4
  v_mul_u32_u24 v4, 5040, v4
  v_add_lshl_u32 v126, v4, v3, 4
  v_add_u32 v3, 2048, v0
  v_mul_u32_u24 v4, 1639, v3
  v_lshrrev_b32 v4, 17, v4
  v_mul_u32_u24 v4, 5040, v4
  v_add_lshl_u32 v127, v4, v3, 4
  v_lshlrev_b32 v128, 2, v0
  v_add_u32 v128, 0, v128
  s_mul_i32 s55, s62, 320
  s_mul_i32 s49, s63, 80
  s_add_u32 s55, s55, s49
  s_lshl_b32 s55, s55, 4
  s_add_u32 s55, s55, 6815744
  v_and_b32 v2, 15, v1
  v_lshrrev_b32 v3, 4, v1
  v_mul_u32_u24 v3, 1280, v3
  v_lshl_add_u32 v2, v2, 2, v3
  s_mul_i32 s48, s44, 10240
  s_add_u32 s48, s48, 0
  v_add_u32 v129, s48, v2
  v_add_u32 v7, s64, v7
  v_add_u32 v8, s64, v8
  v_lshlrev_b32 v15, 4, v1
  v_add_u32 v16, 51200, v15
  v_and_b32 v2, 1, v1
  v_lshlrev_b32 v2, 31, v2
  v_xor_b32 v18, 1.0, v2
  v_xor_b32 v19, 1.0, v2
  s_barrier
  v_add_u32 v13, 92160, v7
  v_add_u32 v14, 92160, v8
  ds_read_b128 v[132:135], v13 offset:0
  ds_read_b128 v[136:139], v13 offset:2048
  ds_read_b128 v[148:151], v15 offset:0
  ds_read_b128 v[152:155], v15 offset:1024
  ds_read_b128 v[156:159], v15 offset:2048
  ds_read_b128 v[160:163], v15 offset:3072
  ds_read_b128 v[164:167], v15 offset:4096
  ds_read_b128 v[168:171], v15 offset:5120
  ds_read_b128 v[172:175], v15 offset:6144
  ds_read_b128 v[176:179], v15 offset:7168
  ds_read_b128 v[180:183], v15 offset:8192
  ds_read_b128 v[184:187], v15 offset:9216
  s_waitcnt lgkmcnt(9)
  v_mfma_f32_16x16x32_bf16 v[44:47], v[132:135], v[148:151], 0
  ds_read_b128 v[140:143], v14 offset:0
  v_mfma_f32_16x16x32_bf16 v[48:51], v[136:139], v[148:151], 0
  ds_read_b128 v[144:147], v14 offset:2048
  s_waitcnt lgkmcnt(10)
  v_mfma_f32_16x16x32_bf16 v[52:55], v[132:135], v[152:155], 0
  ds_read_b128 v[188:191], v15 offset:10240
  v_mfma_f32_16x16x32_bf16 v[56:59], v[136:139], v[152:155], 0
  ds_read_b128 v[192:195], v15 offset:11264
  s_waitcnt lgkmcnt(11)
  v_mfma_f32_16x16x32_bf16 v[60:63], v[132:135], v[156:159], 0
  ds_read_b128 v[196:199], v15 offset:12288
  v_mfma_f32_16x16x32_bf16 v[64:67], v[136:139], v[156:159], 0
  ds_read_b128 v[200:203], v15 offset:13312
  s_waitcnt lgkmcnt(12)
  v_mfma_f32_16x16x32_bf16 v[68:71], v[132:135], v[160:163], 0
  ds_read_b128 v[204:207], v15 offset:14336
  v_mfma_f32_16x16x32_bf16 v[72:75], v[136:139], v[160:163], 0
  ds_read_b128 v[208:211], v15 offset:15360
  s_waitcnt lgkmcnt(13)
  v_mfma_f32_16x16x32_bf16 v[76:79], v[132:135], v[164:167], 0
  ds_read_b128 v[212:215], v15 offset:16384
  v_mfma_f32_16x16x32_bf16 v[80:83], v[136:139], v[164:167], 0
  ds_read_b128 v[216:219], v15 offset:17408
  s_waitcnt lgkmcnt(14)
  v_mfma_f32_16x16x32_bf16 v[84:87], v[132:135], v[168:171], 0
  ds_read_b128 v[220:223], v15 offset:18432
  v_mfma_f32_16x16x32_bf16 v[88:91], v[136:139], v[168:171], 0
  s_waitcnt lgkmcnt(10)
  ds_read_b128 v[224:227], v15 offset:19456
  v_mfma_f32_16x16x32_bf16 v[92:95], v[132:135], v[172:175], 0
  v_mfma_f32_16x16x32_bf16 v[96:99], v[136:139], v[172:175], 0
  v_mfma_f32_16x16x32_bf16 v[100:103], v[132:135], v[176:179], 0
  v_mfma_f32_16x16x32_bf16 v[104:107], v[136:139], v[176:179], 0
  v_mfma_f32_16x16x32_bf16 v[108:111], v[132:135], v[180:183], 0
  v_mfma_f32_16x16x32_bf16 v[112:115], v[136:139], v[180:183], 0
  v_mfma_f32_16x16x32_bf16 v[116:119], v[132:135], v[184:187], 0
  v_mfma_f32_16x16x32_bf16 v[120:123], v[136:139], v[184:187], 0
  s_waitcnt lgkmcnt(9)
  v_mfma_f32_16x16x32_bf16 v[44:47], v[140:143], v[188:191], v[44:47]
  v_mfma_f32_16x16x32_bf16 v[48:51], v[144:147], v[188:191], v[48:51]
  s_barrier
  v_add_u32 v13, 108544, v7
  v_add_u32 v14, 108544, v8
  ds_read_b128 v[132:135], v13 offset:0
  s_waitcnt lgkmcnt(9)
  v_mfma_f32_16x16x32_bf16 v[52:55], v[140:143], v[192:195], v[52:55]
  ds_read_b128 v[136:139], v13 offset:2048
  v_mfma_f32_16x16x32_bf16 v[56:59], v[144:147], v[192:195], v[56:59]
  ds_read_b128 v[148:151], v15 offset:20480
  s_waitcnt lgkmcnt(10)
  v_mfma_f32_16x16x32_bf16 v[60:63], v[140:143], v[196:199], v[60:63]
  ds_read_b128 v[152:155], v15 offset:21504
  v_mfma_f32_16x16x32_bf16 v[64:67], v[144:147], v[196:199], v[64:67]
  ds_read_b128 v[156:159], v15 offset:22528
  s_waitcnt lgkmcnt(11)
  v_mfma_f32_16x16x32_bf16 v[68:71], v[140:143], v[200:203], v[68:71]
  ds_read_b128 v[160:163], v15 offset:23552
  v_mfma_f32_16x16x32_bf16 v[72:75], v[144:147], v[200:203], v[72:75]
  ds_read_b128 v[164:167], v15 offset:24576
  s_waitcnt lgkmcnt(12)
  v_mfma_f32_16x16x32_bf16 v[76:79], v[140:143], v[204:207], v[76:79]
  ds_read_b128 v[168:171], v15 offset:25600
  v_mfma_f32_16x16x32_bf16 v[80:83], v[144:147], v[204:207], v[80:83]
  ds_read_b128 v[172:175], v15 offset:26624
  s_waitcnt lgkmcnt(13)
  v_mfma_f32_16x16x32_bf16 v[84:87], v[140:143], v[208:211], v[84:87]
  ds_read_b128 v[176:179], v15 offset:27648
  v_mfma_f32_16x16x32_bf16 v[88:91], v[144:147], v[208:211], v[88:91]
  ds_read_b128 v[180:183], v15 offset:28672
  s_waitcnt lgkmcnt(14)
  v_mfma_f32_16x16x32_bf16 v[92:95], v[140:143], v[212:215], v[92:95]
  ds_read_b128 v[184:187], v15 offset:29696
  v_mfma_f32_16x16x32_bf16 v[96:99], v[144:147], v[212:215], v[96:99]
  s_waitcnt lgkmcnt(14)
  v_mfma_f32_16x16x32_bf16 v[100:103], v[140:143], v[216:219], v[100:103]
  v_mfma_f32_16x16x32_bf16 v[104:107], v[144:147], v[216:219], v[104:107]
  s_waitcnt lgkmcnt(13)
  v_mfma_f32_16x16x32_bf16 v[108:111], v[140:143], v[220:223], v[108:111]
  v_mfma_f32_16x16x32_bf16 v[112:115], v[144:147], v[220:223], v[112:115]
  s_waitcnt lgkmcnt(12)
  v_mfma_f32_16x16x32_bf16 v[116:119], v[140:143], v[224:227], v[116:119]
  v_mfma_f32_16x16x32_bf16 v[120:123], v[144:147], v[224:227], v[120:123]
  s_waitcnt lgkmcnt(9)
  v_mfma_f32_16x16x32_bf16 v[44:47], v[132:135], v[148:151], v[44:47]
  ds_read_b128 v[140:143], v14 offset:0
  v_mfma_f32_16x16x32_bf16 v[48:51], v[136:139], v[148:151], v[48:51]
  ds_read_b128 v[144:147], v14 offset:2048
  s_waitcnt lgkmcnt(10)
  v_mfma_f32_16x16x32_bf16 v[52:55], v[132:135], v[152:155], v[52:55]
  ds_read_b128 v[188:191], v15 offset:30720
  v_mfma_f32_16x16x32_bf16 v[56:59], v[136:139], v[152:155], v[56:59]
  ds_read_b128 v[192:195], v15 offset:31744
  s_waitcnt lgkmcnt(11)
  v_mfma_f32_16x16x32_bf16 v[60:63], v[132:135], v[156:159], v[60:63]
  ds_read_b128 v[196:199], v15 offset:32768
  v_mfma_f32_16x16x32_bf16 v[64:67], v[136:139], v[156:159], v[64:67]
  ds_read_b128 v[200:203], v15 offset:33792
  s_waitcnt lgkmcnt(12)
  v_mfma_f32_16x16x32_bf16 v[68:71], v[132:135], v[160:163], v[68:71]
  ds_read_b128 v[204:207], v15 offset:34816
  v_mfma_f32_16x16x32_bf16 v[72:75], v[136:139], v[160:163], v[72:75]
  ds_read_b128 v[208:211], v15 offset:35840
  s_waitcnt lgkmcnt(13)
  v_mfma_f32_16x16x32_bf16 v[76:79], v[132:135], v[164:167], v[76:79]
  ds_read_b128 v[212:215], v15 offset:36864
  v_mfma_f32_16x16x32_bf16 v[80:83], v[136:139], v[164:167], v[80:83]
  ds_read_b128 v[216:219], v15 offset:37888
  s_waitcnt lgkmcnt(14)
  v_mfma_f32_16x16x32_bf16 v[84:87], v[132:135], v[168:171], v[84:87]
  ds_read_b128 v[220:223], v15 offset:38912
  v_mfma_f32_16x16x32_bf16 v[88:91], v[136:139], v[168:171], v[88:91]
  s_waitcnt lgkmcnt(10)
  ds_read_b128 v[224:227], v15 offset:39936
  v_mfma_f32_16x16x32_bf16 v[92:95], v[132:135], v[172:175], v[92:95]
  v_mfma_f32_16x16x32_bf16 v[96:99], v[136:139], v[172:175], v[96:99]
  v_mfma_f32_16x16x32_bf16 v[100:103], v[132:135], v[176:179], v[100:103]
  v_mfma_f32_16x16x32_bf16 v[104:107], v[136:139], v[176:179], v[104:107]
  v_mfma_f32_16x16x32_bf16 v[108:111], v[132:135], v[180:183], v[108:111]
  v_mfma_f32_16x16x32_bf16 v[112:115], v[136:139], v[180:183], v[112:115]
  v_mfma_f32_16x16x32_bf16 v[116:119], v[132:135], v[184:187], v[116:119]
  v_mfma_f32_16x16x32_bf16 v[120:123], v[136:139], v[184:187], v[120:123]
  s_waitcnt lgkmcnt(9)
  v_mfma_f32_16x16x32_bf16 v[44:47], v[140:143], v[188:191], v[44:47]
  v_mfma_f32_16x16x32_bf16 v[48:51], v[144:147], v[188:191], v[48:51]
  s_barrier
  v_add_u32 v13, 124928, v7
  v_add_u32 v14, 124928, v8
  ds_read_b128 v[132:135], v13 offset:0
  s_waitcnt lgkmcnt(9)
  v_mfma_f32_16x16x32_bf16 v[52:55], v[140:143], v[192:195], v[52:55]
  ds_read_b128 v[136:139], v13 offset:2048
  v_mfma_f32_16x16x32_bf16 v[56:59], v[144:147], v[192:195], v[56:59]
  ds_read_b128 v[148:151], v15 offset:40960
  s_waitcnt lgkmcnt(10)
  v_mfma_f32_16x16x32_bf16 v[60:63], v[140:143], v[196:199], v[60:63]
  ds_read_b128 v[152:155], v15 offset:41984
  v_mfma_f32_16x16x32_bf16 v[64:67], v[144:147], v[196:199], v[64:67]
  ds_read_b128 v[156:159], v15 offset:43008
  s_waitcnt lgkmcnt(11)
  v_mfma_f32_16x16x32_bf16 v[68:71], v[140:143], v[200:203], v[68:71]
  ds_read_b128 v[160:163], v15 offset:44032
  v_mfma_f32_16x16x32_bf16 v[72:75], v[144:147], v[200:203], v[72:75]
  ds_read_b128 v[164:167], v15 offset:45056
  s_waitcnt lgkmcnt(12)
  v_mfma_f32_16x16x32_bf16 v[76:79], v[140:143], v[204:207], v[76:79]
  ds_read_b128 v[168:171], v15 offset:46080
  v_mfma_f32_16x16x32_bf16 v[80:83], v[144:147], v[204:207], v[80:83]
  ds_read_b128 v[172:175], v15 offset:47104
  s_waitcnt lgkmcnt(13)
  v_mfma_f32_16x16x32_bf16 v[84:87], v[140:143], v[208:211], v[84:87]
  ds_read_b128 v[176:179], v15 offset:48128
  v_mfma_f32_16x16x32_bf16 v[88:91], v[144:147], v[208:211], v[88:91]
  ds_read_b128 v[180:183], v15 offset:49152
  s_waitcnt lgkmcnt(14)
  v_mfma_f32_16x16x32_bf16 v[92:95], v[140:143], v[212:215], v[92:95]
  ds_read_b128 v[184:187], v15 offset:50176
  v_mfma_f32_16x16x32_bf16 v[96:99], v[144:147], v[212:215], v[96:99]
  s_waitcnt lgkmcnt(14)
  v_mfma_f32_16x16x32_bf16 v[100:103], v[140:143], v[216:219], v[100:103]
  v_mfma_f32_16x16x32_bf16 v[104:107], v[144:147], v[216:219], v[104:107]
  s_waitcnt lgkmcnt(13)
  v_mfma_f32_16x16x32_bf16 v[108:111], v[140:143], v[220:223], v[108:111]
  v_mfma_f32_16x16x32_bf16 v[112:115], v[144:147], v[220:223], v[112:115]
  s_waitcnt lgkmcnt(12)
  v_mfma_f32_16x16x32_bf16 v[116:119], v[140:143], v[224:227], v[116:119]
  v_mfma_f32_16x16x32_bf16 v[120:123], v[144:147], v[224:227], v[120:123]
  s_waitcnt lgkmcnt(9)
  v_mfma_f32_16x16x32_bf16 v[44:47], v[132:135], v[148:151], v[44:47]
  ds_read_b128 v[140:143], v14 offset:0
  v_mfma_f32_16x16x32_bf16 v[48:51], v[136:139], v[148:151], v[48:51]
  ds_read_b128 v[144:147], v14 offset:2048
  s_waitcnt lgkmcnt(10)
  v_mfma_f32_16x16x32_bf16 v[52:55], v[132:135], v[152:155], v[52:55]
  ds_read_b128 v[188:191], v16 offset:0
  v_mfma_f32_16x16x32_bf16 v[56:59], v[136:139], v[152:155], v[56:59]
  ds_read_b128 v[192:195], v16 offset:1024
  s_waitcnt lgkmcnt(11)
  v_mfma_f32_16x16x32_bf16 v[60:63], v[132:135], v[156:159], v[60:63]
  ds_read_b128 v[196:199], v16 offset:2048
  v_mfma_f32_16x16x32_bf16 v[64:67], v[136:139], v[156:159], v[64:67]
  ds_read_b128 v[200:203], v16 offset:3072
  s_waitcnt lgkmcnt(12)
  v_mfma_f32_16x16x32_bf16 v[68:71], v[132:135], v[160:163], v[68:71]
  ds_read_b128 v[204:207], v16 offset:4096
  v_mfma_f32_16x16x32_bf16 v[72:75], v[136:139], v[160:163], v[72:75]
  ds_read_b128 v[208:211], v16 offset:5120
  s_waitcnt lgkmcnt(13)
  v_mfma_f32_16x16x32_bf16 v[76:79], v[132:135], v[164:167], v[76:79]
  ds_read_b128 v[212:215], v16 offset:6144
  v_mfma_f32_16x16x32_bf16 v[80:83], v[136:139], v[164:167], v[80:83]
  ds_read_b128 v[216:219], v16 offset:7168
  s_waitcnt lgkmcnt(14)
  v_mfma_f32_16x16x32_bf16 v[84:87], v[132:135], v[168:171], v[84:87]
  ds_read_b128 v[220:223], v16 offset:8192
  v_mfma_f32_16x16x32_bf16 v[88:91], v[136:139], v[168:171], v[88:91]
  s_waitcnt lgkmcnt(10)
  ds_read_b128 v[224:227], v16 offset:9216
  v_mfma_f32_16x16x32_bf16 v[92:95], v[132:135], v[172:175], v[92:95]
  v_mfma_f32_16x16x32_bf16 v[96:99], v[136:139], v[172:175], v[96:99]
  v_mfma_f32_16x16x32_bf16 v[100:103], v[132:135], v[176:179], v[100:103]
  v_mfma_f32_16x16x32_bf16 v[104:107], v[136:139], v[176:179], v[104:107]
  v_mfma_f32_16x16x32_bf16 v[108:111], v[132:135], v[180:183], v[108:111]
  v_mfma_f32_16x16x32_bf16 v[112:115], v[136:139], v[180:183], v[112:115]
  v_mfma_f32_16x16x32_bf16 v[116:119], v[132:135], v[184:187], v[116:119]
  v_mfma_f32_16x16x32_bf16 v[120:123], v[136:139], v[184:187], v[120:123]
  s_waitcnt lgkmcnt(9)
  v_mfma_f32_16x16x32_bf16 v[44:47], v[140:143], v[188:191], v[44:47]
  v_mfma_f32_16x16x32_bf16 v[48:51], v[144:147], v[188:191], v[48:51]
  s_barrier
  v_add_u32 v13, 92160, v7
  v_add_u32 v14, 92160, v8
  ds_read_b128 v[132:135], v13 offset:0
  s_waitcnt lgkmcnt(9)
  v_mfma_f32_16x16x32_bf16 v[52:55], v[140:143], v[192:195], v[52:55]
  ds_read_b128 v[136:139], v13 offset:2048
  v_mfma_f32_16x16x32_bf16 v[56:59], v[144:147], v[192:195], v[56:59]
  ds_read_b128 v[148:151], v16 offset:10240
  s_waitcnt lgkmcnt(10)
  v_mfma_f32_16x16x32_bf16 v[60:63], v[140:143], v[196:199], v[60:63]
  ds_read_b128 v[152:155], v16 offset:11264
  v_mfma_f32_16x16x32_bf16 v[64:67], v[144:147], v[196:199], v[64:67]
  ds_read_b128 v[156:159], v16 offset:12288
  s_waitcnt lgkmcnt(11)
  v_mfma_f32_16x16x32_bf16 v[68:71], v[140:143], v[200:203], v[68:71]
  ds_read_b128 v[160:163], v16 offset:13312
  v_mfma_f32_16x16x32_bf16 v[72:75], v[144:147], v[200:203], v[72:75]
  ds_read_b128 v[164:167], v16 offset:14336
  s_waitcnt lgkmcnt(12)
  v_mfma_f32_16x16x32_bf16 v[76:79], v[140:143], v[204:207], v[76:79]
  ds_read_b128 v[168:171], v16 offset:15360
  v_mfma_f32_16x16x32_bf16 v[80:83], v[144:147], v[204:207], v[80:83]
  ds_read_b128 v[172:175], v16 offset:16384
  s_waitcnt lgkmcnt(13)
  v_mfma_f32_16x16x32_bf16 v[84:87], v[140:143], v[208:211], v[84:87]
  ds_read_b128 v[176:179], v16 offset:17408
  v_mfma_f32_16x16x32_bf16 v[88:91], v[144:147], v[208:211], v[88:91]
  ds_read_b128 v[180:183], v16 offset:18432
  s_waitcnt lgkmcnt(14)
  v_mfma_f32_16x16x32_bf16 v[92:95], v[140:143], v[212:215], v[92:95]
  ds_read_b128 v[184:187], v16 offset:19456
  v_mfma_f32_16x16x32_bf16 v[96:99], v[144:147], v[212:215], v[96:99]
  s_waitcnt lgkmcnt(14)
  v_mfma_f32_16x16x32_bf16 v[100:103], v[140:143], v[216:219], v[100:103]
  v_mfma_f32_16x16x32_bf16 v[104:107], v[144:147], v[216:219], v[104:107]
  s_waitcnt lgkmcnt(13)
  v_mfma_f32_16x16x32_bf16 v[108:111], v[140:143], v[220:223], v[108:111]
  v_mfma_f32_16x16x32_bf16 v[112:115], v[144:147], v[220:223], v[112:115]
  s_waitcnt lgkmcnt(12)
  v_mfma_f32_16x16x32_bf16 v[116:119], v[140:143], v[224:227], v[116:119]
  v_mfma_f32_16x16x32_bf16 v[120:123], v[144:147], v[224:227], v[120:123]
  s_waitcnt lgkmcnt(9)
  v_mfma_f32_16x16x32_bf16 v[44:47], v[132:135], v[148:151], v[44:47]
  ds_read_b128 v[140:143], v14 offset:0
  v_mfma_f32_16x16x32_bf16 v[48:51], v[136:139], v[148:151], v[48:51]
  ds_read_b128 v[144:147], v14 offset:2048
  s_waitcnt lgkmcnt(10)
  v_mfma_f32_16x16x32_bf16 v[52:55], v[132:135], v[152:155], v[52:55]
  ds_read_b128 v[188:191], v16 offset:20480
  v_mfma_f32_16x16x32_bf16 v[56:59], v[136:139], v[152:155], v[56:59]
  ds_read_b128 v[192:195], v16 offset:21504
  s_waitcnt lgkmcnt(11)
  v_mfma_f32_16x16x32_bf16 v[60:63], v[132:135], v[156:159], v[60:63]
  ds_read_b128 v[196:199], v16 offset:22528
  v_mfma_f32_16x16x32_bf16 v[64:67], v[136:139], v[156:159], v[64:67]
  ds_read_b128 v[200:203], v16 offset:23552
  s_waitcnt lgkmcnt(12)
  v_mfma_f32_16x16x32_bf16 v[68:71], v[132:135], v[160:163], v[68:71]
  ds_read_b128 v[204:207], v16 offset:24576
  v_mfma_f32_16x16x32_bf16 v[72:75], v[136:139], v[160:163], v[72:75]
  ds_read_b128 v[208:211], v16 offset:25600
  s_waitcnt lgkmcnt(13)
  v_mfma_f32_16x16x32_bf16 v[76:79], v[132:135], v[164:167], v[76:79]
  ds_read_b128 v[212:215], v16 offset:26624
  v_mfma_f32_16x16x32_bf16 v[80:83], v[136:139], v[164:167], v[80:83]
  ds_read_b128 v[216:219], v16 offset:27648
  s_waitcnt lgkmcnt(14)
  v_mfma_f32_16x16x32_bf16 v[84:87], v[132:135], v[168:171], v[84:87]
  ds_read_b128 v[220:223], v16 offset:28672
  v_mfma_f32_16x16x32_bf16 v[88:91], v[136:139], v[168:171], v[88:91]
  s_waitcnt lgkmcnt(10)
  ds_read_b128 v[224:227], v16 offset:29696
  v_mfma_f32_16x16x32_bf16 v[92:95], v[132:135], v[172:175], v[92:95]
  v_mfma_f32_16x16x32_bf16 v[96:99], v[136:139], v[172:175], v[96:99]
  v_mfma_f32_16x16x32_bf16 v[100:103], v[132:135], v[176:179], v[100:103]
  v_mfma_f32_16x16x32_bf16 v[104:107], v[136:139], v[176:179], v[104:107]
  v_mfma_f32_16x16x32_bf16 v[108:111], v[132:135], v[180:183], v[108:111]
  v_mfma_f32_16x16x32_bf16 v[112:115], v[136:139], v[180:183], v[112:115]
  v_mfma_f32_16x16x32_bf16 v[116:119], v[132:135], v[184:187], v[116:119]
  v_mfma_f32_16x16x32_bf16 v[120:123], v[136:139], v[184:187], v[120:123]
  s_waitcnt lgkmcnt(9)
  v_mfma_f32_16x16x32_bf16 v[44:47], v[140:143], v[188:191], v[44:47]
  v_mfma_f32_16x16x32_bf16 v[48:51], v[144:147], v[188:191], v[48:51]
  s_barrier
  v_add_u32 v13, 108544, v7
  v_add_u32 v14, 108544, v8
  ds_read_b128 v[132:135], v13 offset:0
  s_waitcnt lgkmcnt(9)
  v_mfma_f32_16x16x32_bf16 v[52:55], v[140:143], v[192:195], v[52:55]
  ds_read_b128 v[136:139], v13 offset:2048
  v_mfma_f32_16x16x32_bf16 v[56:59], v[144:147], v[192:195], v[56:59]
  ds_read_b128 v[148:151], v16 offset:30720
  s_waitcnt lgkmcnt(10)
  v_mfma_f32_16x16x32_bf16 v[60:63], v[140:143], v[196:199], v[60:63]
  ds_read_b128 v[152:155], v16 offset:31744
  v_mfma_f32_16x16x32_bf16 v[64:67], v[144:147], v[196:199], v[64:67]
  ds_read_b128 v[156:159], v16 offset:32768
  s_waitcnt lgkmcnt(11)
  v_mfma_f32_16x16x32_bf16 v[68:71], v[140:143], v[200:203], v[68:71]
  ds_read_b128 v[160:163], v16 offset:33792
  v_mfma_f32_16x16x32_bf16 v[72:75], v[144:147], v[200:203], v[72:75]
  ds_read_b128 v[164:167], v16 offset:34816
  s_waitcnt lgkmcnt(12)
  v_mfma_f32_16x16x32_bf16 v[76:79], v[140:143], v[204:207], v[76:79]
  ds_read_b128 v[168:171], v16 offset:35840
  v_mfma_f32_16x16x32_bf16 v[80:83], v[144:147], v[204:207], v[80:83]
  ds_read_b128 v[172:175], v16 offset:36864
  s_waitcnt lgkmcnt(13)
  v_mfma_f32_16x16x32_bf16 v[84:87], v[140:143], v[208:211], v[84:87]
  ds_read_b128 v[176:179], v16 offset:37888
  v_mfma_f32_16x16x32_bf16 v[88:91], v[144:147], v[208:211], v[88:91]
  ds_read_b128 v[180:183], v16 offset:38912
  s_waitcnt lgkmcnt(14)
  v_mfma_f32_16x16x32_bf16 v[92:95], v[140:143], v[212:215], v[92:95]
  ds_read_b128 v[184:187], v16 offset:39936
  v_mfma_f32_16x16x32_bf16 v[96:99], v[144:147], v[212:215], v[96:99]
  s_waitcnt lgkmcnt(14)
  v_mfma_f32_16x16x32_bf16 v[100:103], v[140:143], v[216:219], v[100:103]
  v_mfma_f32_16x16x32_bf16 v[104:107], v[144:147], v[216:219], v[104:107]
  s_waitcnt lgkmcnt(13)
  v_mfma_f32_16x16x32_bf16 v[108:111], v[140:143], v[220:223], v[108:111]
  v_mfma_f32_16x16x32_bf16 v[112:115], v[144:147], v[220:223], v[112:115]
  s_waitcnt lgkmcnt(12)
  v_mfma_f32_16x16x32_bf16 v[116:119], v[140:143], v[224:227], v[116:119]
  v_mfma_f32_16x16x32_bf16 v[120:123], v[144:147], v[224:227], v[120:123]
  s_waitcnt lgkmcnt(9)
  v_mfma_f32_16x16x32_bf16 v[44:47], v[132:135], v[148:151], v[44:47]
  ds_read_b128 v[140:143], v14 offset:0
  v_mfma_f32_16x16x32_bf16 v[48:51], v[136:139], v[148:151], v[48:51]
  ds_read_b128 v[144:147], v14 offset:2048
  s_waitcnt lgkmcnt(10)
  v_mfma_f32_16x16x32_bf16 v[52:55], v[132:135], v[152:155], v[52:55]
  ds_read_b128 v[188:191], v15 offset:0
  v_mfma_f32_16x16x32_bf16 v[56:59], v[136:139], v[152:155], v[56:59]
  ds_read_b128 v[192:195], v15 offset:1024
  s_waitcnt lgkmcnt(11)
  v_mfma_f32_16x16x32_bf16 v[60:63], v[132:135], v[156:159], v[60:63]
  ds_read_b128 v[196:199], v15 offset:2048
  v_mfma_f32_16x16x32_bf16 v[64:67], v[136:139], v[156:159], v[64:67]
  ds_read_b128 v[200:203], v15 offset:3072
  s_waitcnt lgkmcnt(12)
  v_mfma_f32_16x16x32_bf16 v[68:71], v[132:135], v[160:163], v[68:71]
  ds_read_b128 v[204:207], v15 offset:4096
  v_mfma_f32_16x16x32_bf16 v[72:75], v[136:139], v[160:163], v[72:75]
  ds_read_b128 v[208:211], v15 offset:5120
  s_waitcnt lgkmcnt(13)
  v_mfma_f32_16x16x32_bf16 v[76:79], v[132:135], v[164:167], v[76:79]
  ds_read_b128 v[212:215], v15 offset:6144
  v_mfma_f32_16x16x32_bf16 v[80:83], v[136:139], v[164:167], v[80:83]
  ds_read_b128 v[216:219], v15 offset:7168
  s_waitcnt lgkmcnt(14)
  v_mfma_f32_16x16x32_bf16 v[84:87], v[132:135], v[168:171], v[84:87]
  ds_read_b128 v[220:223], v15 offset:8192
  v_mfma_f32_16x16x32_bf16 v[88:91], v[136:139], v[168:171], v[88:91]
  s_waitcnt lgkmcnt(10)
  ds_read_b128 v[224:227], v15 offset:9216
  v_mfma_f32_16x16x32_bf16 v[92:95], v[132:135], v[172:175], v[92:95]
  v_mfma_f32_16x16x32_bf16 v[96:99], v[136:139], v[172:175], v[96:99]
  v_mfma_f32_16x16x32_bf16 v[100:103], v[132:135], v[176:179], v[100:103]
  v_mfma_f32_16x16x32_bf16 v[104:107], v[136:139], v[176:179], v[104:107]
  v_mfma_f32_16x16x32_bf16 v[108:111], v[132:135], v[180:183], v[108:111]
  v_mfma_f32_16x16x32_bf16 v[112:115], v[136:139], v[180:183], v[112:115]
  v_mfma_f32_16x16x32_bf16 v[116:119], v[132:135], v[184:187], v[116:119]
  v_mfma_f32_16x16x32_bf16 v[120:123], v[136:139], v[184:187], v[120:123]
  s_waitcnt lgkmcnt(9)
  v_pk_mul_f32 v[44:45], v[44:45], v[18:19]
  v_pk_mul_f32 v[46:47], v[46:47], v[18:19]
  v_pk_mul_f32 v[48:49], v[48:49], v[18:19]
  v_pk_mul_f32 v[50:51], v[50:51], v[18:19]
  v_pk_mul_f32 v[52:53], v[52:53], v[18:19]
  v_pk_mul_f32 v[54:55], v[54:55], v[18:19]
  v_mfma_f32_16x16x32_bf16 v[44:47], v[140:143], v[188:191], v[44:47]
  v_pk_mul_f32 v[56:57], v[56:57], v[18:19]
  v_pk_mul_f32 v[58:59], v[58:59], v[18:19]
  v_mfma_f32_16x16x32_bf16 v[48:51], v[144:147], v[188:191], v[48:51]
  s_barrier
  v_add_u32 v13, 124928, v7
  v_add_u32 v14, 124928, v8
  ds_read_b128 v[132:135], v13 offset:0
  s_waitcnt lgkmcnt(9)
  v_pk_mul_f32 v[60:61], v[60:61], v[18:19]
  v_pk_mul_f32 v[62:63], v[62:63], v[18:19]
  v_mfma_f32_16x16x32_bf16 v[52:55], v[140:143], v[192:195], v[52:55]
  ds_read_b128 v[136:139], v13 offset:2048
  v_pk_mul_f32 v[64:65], v[64:65], v[18:19]
  v_pk_mul_f32 v[66:67], v[66:67], v[18:19]
  v_mfma_f32_16x16x32_bf16 v[56:59], v[144:147], v[192:195], v[56:59]
  ds_read_b128 v[148:151], v15 offset:10240
  s_waitcnt lgkmcnt(10)
  v_pk_mul_f32 v[68:69], v[68:69], v[18:19]
  v_pk_mul_f32 v[70:71], v[70:71], v[18:19]
  v_mfma_f32_16x16x32_bf16 v[60:63], v[140:143], v[196:199], v[60:63]
  ds_read_b128 v[152:155], v15 offset:11264
  v_pk_mul_f32 v[72:73], v[72:73], v[18:19]
  v_pk_mul_f32 v[74:75], v[74:75], v[18:19]
  v_mfma_f32_16x16x32_bf16 v[64:67], v[144:147], v[196:199], v[64:67]
  ds_read_b128 v[156:159], v15 offset:12288
  s_waitcnt lgkmcnt(11)
  v_pk_mul_f32 v[76:77], v[76:77], v[18:19]
  v_pk_mul_f32 v[78:79], v[78:79], v[18:19]
  v_mfma_f32_16x16x32_bf16 v[68:71], v[140:143], v[200:203], v[68:71]
  ds_read_b128 v[160:163], v15 offset:13312
  v_pk_mul_f32 v[80:81], v[80:81], v[18:19]
  v_pk_mul_f32 v[82:83], v[82:83], v[18:19]
  v_mfma_f32_16x16x32_bf16 v[72:75], v[144:147], v[200:203], v[72:75]
  ds_read_b128 v[164:167], v15 offset:14336
  s_waitcnt lgkmcnt(12)
  v_pk_mul_f32 v[84:85], v[84:85], v[18:19]
  v_pk_mul_f32 v[86:87], v[86:87], v[18:19]
  v_mfma_f32_16x16x32_bf16 v[76:79], v[140:143], v[204:207], v[76:79]
  ds_read_b128 v[168:171], v15 offset:15360
  v_pk_mul_f32 v[88:89], v[88:89], v[18:19]
  v_pk_mul_f32 v[90:91], v[90:91], v[18:19]
  v_mfma_f32_16x16x32_bf16 v[80:83], v[144:147], v[204:207], v[80:83]
  ds_read_b128 v[172:175], v15 offset:16384
  s_waitcnt lgkmcnt(13)
  v_pk_mul_f32 v[92:93], v[92:93], v[18:19]
  v_pk_mul_f32 v[94:95], v[94:95], v[18:19]
  v_mfma_f32_16x16x32_bf16 v[84:87], v[140:143], v[208:211], v[84:87]
  ds_read_b128 v[176:179], v15 offset:17408
  v_pk_mul_f32 v[96:97], v[96:97], v[18:19]
  v_pk_mul_f32 v[98:99], v[98:99], v[18:19]
  v_mfma_f32_16x16x32_bf16 v[88:91], v[144:147], v[208:211], v[88:91]
  ds_read_b128 v[180:183], v15 offset:18432
  s_waitcnt lgkmcnt(14)
  v_pk_mul_f32 v[100:101], v[100:101], v[18:19]
  v_pk_mul_f32 v[102:103], v[102:103], v[18:19]
  v_mfma_f32_16x16x32_bf16 v[92:95], v[140:143], v[212:215], v[92:95]
  ds_read_b128 v[184:187], v15 offset:19456
  v_pk_mul_f32 v[104:105], v[104:105], v[18:19]
  v_pk_mul_f32 v[106:107], v[106:107], v[18:19]
  v_mfma_f32_16x16x32_bf16 v[96:99], v[144:147], v[212:215], v[96:99]
  s_waitcnt lgkmcnt(14)
  v_pk_mul_f32 v[108:109], v[108:109], v[18:19]
  v_pk_mul_f32 v[110:111], v[110:111], v[18:19]
  v_mfma_f32_16x16x32_bf16 v[100:103], v[140:143], v[216:219], v[100:103]
  v_pk_mul_f32 v[112:113], v[112:113], v[18:19]
  v_pk_mul_f32 v[114:115], v[114:115], v[18:19]
  v_mfma_f32_16x16x32_bf16 v[104:107], v[144:147], v[216:219], v[104:107]
  s_waitcnt lgkmcnt(13)
  v_pk_mul_f32 v[116:117], v[116:117], v[18:19]
  v_pk_mul_f32 v[118:119], v[118:119], v[18:19]
  v_mfma_f32_16x16x32_bf16 v[108:111], v[140:143], v[220:223], v[108:111]
  v_pk_mul_f32 v[120:121], v[120:121], v[18:19]
  v_pk_mul_f32 v[122:123], v[122:123], v[18:19]
  v_mfma_f32_16x16x32_bf16 v[112:115], v[144:147], v[220:223], v[112:115]
  s_waitcnt lgkmcnt(12)
  v_mfma_f32_16x16x32_bf16 v[116:119], v[140:143], v[224:227], v[116:119]
  v_mfma_f32_16x16x32_bf16 v[120:123], v[144:147], v[224:227], v[120:123]
  s_waitcnt lgkmcnt(9)
  v_mfma_f32_16x16x32_bf16 v[44:47], v[132:135], v[148:151], v[44:47]
  ds_read_b128 v[140:143], v14 offset:0
  v_mfma_f32_16x16x32_bf16 v[48:51], v[136:139], v[148:151], v[48:51]
  ds_read_b128 v[144:147], v14 offset:2048
  s_waitcnt lgkmcnt(10)
  v_mfma_f32_16x16x32_bf16 v[52:55], v[132:135], v[152:155], v[52:55]
  ds_read_b128 v[188:191], v15 offset:20480
  v_mfma_f32_16x16x32_bf16 v[56:59], v[136:139], v[152:155], v[56:59]
  ds_read_b128 v[192:195], v15 offset:21504
  s_waitcnt lgkmcnt(11)
  v_mfma_f32_16x16x32_bf16 v[60:63], v[132:135], v[156:159], v[60:63]
  ds_read_b128 v[196:199], v15 offset:22528
  v_mfma_f32_16x16x32_bf16 v[64:67], v[136:139], v[156:159], v[64:67]
  ds_read_b128 v[200:203], v15 offset:23552
  s_waitcnt lgkmcnt(12)
  v_mfma_f32_16x16x32_bf16 v[68:71], v[132:135], v[160:163], v[68:71]
  ds_read_b128 v[204:207], v15 offset:24576
  v_mfma_f32_16x16x32_bf16 v[72:75], v[136:139], v[160:163], v[72:75]
  ds_read_b128 v[208:211], v15 offset:25600
  s_waitcnt lgkmcnt(13)
  v_mfma_f32_16x16x32_bf16 v[76:79], v[132:135], v[164:167], v[76:79]
  ds_read_b128 v[212:215], v15 offset:26624
  v_mfma_f32_16x16x32_bf16 v[80:83], v[136:139], v[164:167], v[80:83]
  ds_read_b128 v[216:219], v15 offset:27648
  s_waitcnt lgkmcnt(14)
  v_mfma_f32_16x16x32_bf16 v[84:87], v[132:135], v[168:171], v[84:87]
  ds_read_b128 v[220:223], v15 offset:28672
  v_mfma_f32_16x16x32_bf16 v[88:91], v[136:139], v[168:171], v[88:91]
  s_waitcnt lgkmcnt(10)
  ds_read_b128 v[224:227], v15 offset:29696
  v_mfma_f32_16x16x32_bf16 v[92:95], v[132:135], v[172:175], v[92:95]
  v_mfma_f32_16x16x32_bf16 v[96:99], v[136:139], v[172:175], v[96:99]
  v_mfma_f32_16x16x32_bf16 v[100:103], v[132:135], v[176:179], v[100:103]
  v_mfma_f32_16x16x32_bf16 v[104:107], v[136:139], v[176:179], v[104:107]
  v_mfma_f32_16x16x32_bf16 v[108:111], v[132:135], v[180:183], v[108:111]
  v_mfma_f32_16x16x32_bf16 v[112:115], v[136:139], v[180:183], v[112:115]
  v_mfma_f32_16x16x32_bf16 v[116:119], v[132:135], v[184:187], v[116:119]
  v_mfma_f32_16x16x32_bf16 v[120:123], v[136:139], v[184:187], v[120:123]
  s_waitcnt lgkmcnt(9)
  v_mfma_f32_16x16x32_bf16 v[44:47], v[140:143], v[188:191], v[44:47]
  v_mfma_f32_16x16x32_bf16 v[48:51], v[144:147], v[188:191], v[48:51]
  s_barrier
  v_add_u32 v13, 92160, v7
  v_add_u32 v14, 92160, v8
  ds_read_b128 v[132:135], v13 offset:0
  s_waitcnt lgkmcnt(9)
  v_mfma_f32_16x16x32_bf16 v[52:55], v[140:143], v[192:195], v[52:55]
  ds_read_b128 v[136:139], v13 offset:2048
  v_mfma_f32_16x16x32_bf16 v[56:59], v[144:147], v[192:195], v[56:59]
  ds_read_b128 v[148:151], v15 offset:30720
  s_waitcnt lgkmcnt(10)
  v_mfma_f32_16x16x32_bf16 v[60:63], v[140:143], v[196:199], v[60:63]
  ds_read_b128 v[152:155], v15 offset:31744
  v_mfma_f32_16x16x32_bf16 v[64:67], v[144:147], v[196:199], v[64:67]
  ds_read_b128 v[156:159], v15 offset:32768
  s_waitcnt lgkmcnt(11)
  v_mfma_f32_16x16x32_bf16 v[68:71], v[140:143], v[200:203], v[68:71]
  ds_read_b128 v[160:163], v15 offset:33792
  v_mfma_f32_16x16x32_bf16 v[72:75], v[144:147], v[200:203], v[72:75]
  ds_read_b128 v[164:167], v15 offset:34816
  s_waitcnt lgkmcnt(12)
  v_mfma_f32_16x16x32_bf16 v[76:79], v[140:143], v[204:207], v[76:79]
  ds_read_b128 v[168:171], v15 offset:35840
  v_mfma_f32_16x16x32_bf16 v[80:83], v[144:147], v[204:207], v[80:83]
  ds_read_b128 v[172:175], v15 offset:36864
  s_waitcnt lgkmcnt(13)
  v_mfma_f32_16x16x32_bf16 v[84:87], v[140:143], v[208:211], v[84:87]
  ds_read_b128 v[176:179], v15 offset:37888
  v_mfma_f32_16x16x32_bf16 v[88:91], v[144:147], v[208:211], v[88:91]
  ds_read_b128 v[180:183], v15 offset:38912
  s_waitcnt lgkmcnt(14)
  v_mfma_f32_16x16x32_bf16 v[92:95], v[140:143], v[212:215], v[92:95]
  ds_read_b128 v[184:187], v15 offset:39936
  v_mfma_f32_16x16x32_bf16 v[96:99], v[144:147], v[212:215], v[96:99]
  s_waitcnt lgkmcnt(14)
  v_mfma_f32_16x16x32_bf16 v[100:103], v[140:143], v[216:219], v[100:103]
  v_mfma_f32_16x16x32_bf16 v[104:107], v[144:147], v[216:219], v[104:107]
  s_waitcnt lgkmcnt(13)
  v_mfma_f32_16x16x32_bf16 v[108:111], v[140:143], v[220:223], v[108:111]
  v_mfma_f32_16x16x32_bf16 v[112:115], v[144:147], v[220:223], v[112:115]
  s_waitcnt lgkmcnt(12)
  v_mfma_f32_16x16x32_bf16 v[116:119], v[140:143], v[224:227], v[116:119]
  v_mfma_f32_16x16x32_bf16 v[120:123], v[144:147], v[224:227], v[120:123]
  s_waitcnt lgkmcnt(9)
  v_mfma_f32_16x16x32_bf16 v[44:47], v[132:135], v[148:151], v[44:47]
  ds_read_b128 v[140:143], v14 offset:0
  v_mfma_f32_16x16x32_bf16 v[48:51], v[136:139], v[148:151], v[48:51]
  ds_read_b128 v[144:147], v14 offset:2048
  s_waitcnt lgkmcnt(10)
  v_mfma_f32_16x16x32_bf16 v[52:55], v[132:135], v[152:155], v[52:55]
  ds_read_b128 v[188:191], v15 offset:40960
  v_mfma_f32_16x16x32_bf16 v[56:59], v[136:139], v[152:155], v[56:59]
  ds_read_b128 v[192:195], v15 offset:41984
  s_waitcnt lgkmcnt(11)
  v_mfma_f32_16x16x32_bf16 v[60:63], v[132:135], v[156:159], v[60:63]
  ds_read_b128 v[196:199], v15 offset:43008
  v_mfma_f32_16x16x32_bf16 v[64:67], v[136:139], v[156:159], v[64:67]
  ds_read_b128 v[200:203], v15 offset:44032
  s_waitcnt lgkmcnt(12)
  v_mfma_f32_16x16x32_bf16 v[68:71], v[132:135], v[160:163], v[68:71]
  ds_read_b128 v[204:207], v15 offset:45056
  v_mfma_f32_16x16x32_bf16 v[72:75], v[136:139], v[160:163], v[72:75]
  ds_read_b128 v[208:211], v15 offset:46080
  s_waitcnt lgkmcnt(13)
  v_mfma_f32_16x16x32_bf16 v[76:79], v[132:135], v[164:167], v[76:79]
  ds_read_b128 v[212:215], v15 offset:47104
  v_mfma_f32_16x16x32_bf16 v[80:83], v[136:139], v[164:167], v[80:83]
  ds_read_b128 v[216:219], v15 offset:48128
  s_waitcnt lgkmcnt(14)
  v_mfma_f32_16x16x32_bf16 v[84:87], v[132:135], v[168:171], v[84:87]
  ds_read_b128 v[220:223], v15 offset:49152
  v_mfma_f32_16x16x32_bf16 v[88:91], v[136:139], v[168:171], v[88:91]
  s_waitcnt lgkmcnt(10)
  ds_read_b128 v[224:227], v15 offset:50176
  v_mfma_f32_16x16x32_bf16 v[92:95], v[132:135], v[172:175], v[92:95]
  v_mfma_f32_16x16x32_bf16 v[96:99], v[136:139], v[172:175], v[96:99]
  v_mfma_f32_16x16x32_bf16 v[100:103], v[132:135], v[176:179], v[100:103]
  v_mfma_f32_16x16x32_bf16 v[104:107], v[136:139], v[176:179], v[104:107]
  v_mfma_f32_16x16x32_bf16 v[108:111], v[132:135], v[180:183], v[108:111]
  v_mfma_f32_16x16x32_bf16 v[112:115], v[136:139], v[180:183], v[112:115]
  v_mfma_f32_16x16x32_bf16 v[116:119], v[132:135], v[184:187], v[116:119]
  v_mfma_f32_16x16x32_bf16 v[120:123], v[136:139], v[184:187], v[120:123]
  s_waitcnt lgkmcnt(9)
  v_mfma_f32_16x16x32_bf16 v[44:47], v[140:143], v[188:191], v[44:47]
  v_mfma_f32_16x16x32_bf16 v[48:51], v[144:147], v[188:191], v[48:51]
  s_barrier
  v_add_u32 v13, 108544, v7
  v_add_u32 v14, 108544, v8
  ds_read_b128 v[132:135], v13 offset:0
  s_waitcnt lgkmcnt(9)
  v_mfma_f32_16x16x32_bf16 v[52:55], v[140:143], v[192:195], v[52:55]
  ds_read_b128 v[136:139], v13 offset:2048
  v_mfma_f32_16x16x32_bf16 v[56:59], v[144:147], v[192:195], v[56:59]
  ds_read_b128 v[148:151], v16 offset:0
  s_waitcnt lgkmcnt(10)
  v_mfma_f32_16x16x32_bf16 v[60:63], v[140:143], v[196:199], v[60:63]
  ds_read_b128 v[152:155], v16 offset:1024
  v_mfma_f32_16x16x32_bf16 v[64:67], v[144:147], v[196:199], v[64:67]
  ds_read_b128 v[156:159], v16 offset:2048
  s_waitcnt lgkmcnt(11)
  v_mfma_f32_16x16x32_bf16 v[68:71], v[140:143], v[200:203], v[68:71]
  ds_read_b128 v[160:163], v16 offset:3072
  v_mfma_f32_16x16x32_bf16 v[72:75], v[144:147], v[200:203], v[72:75]
  ds_read_b128 v[164:167], v16 offset:4096
  s_waitcnt lgkmcnt(12)
  v_mfma_f32_16x16x32_bf16 v[76:79], v[140:143], v[204:207], v[76:79]
  ds_read_b128 v[168:171], v16 offset:5120
  v_mfma_f32_16x16x32_bf16 v[80:83], v[144:147], v[204:207], v[80:83]
  ds_read_b128 v[172:175], v16 offset:6144
  s_waitcnt lgkmcnt(13)
  v_mfma_f32_16x16x32_bf16 v[84:87], v[140:143], v[208:211], v[84:87]
  ds_read_b128 v[176:179], v16 offset:7168
  v_mfma_f32_16x16x32_bf16 v[88:91], v[144:147], v[208:211], v[88:91]
  ds_read_b128 v[180:183], v16 offset:8192
  s_waitcnt lgkmcnt(14)
  v_mfma_f32_16x16x32_bf16 v[92:95], v[140:143], v[212:215], v[92:95]
  ds_read_b128 v[184:187], v16 offset:9216
  v_mfma_f32_16x16x32_bf16 v[96:99], v[144:147], v[212:215], v[96:99]
  s_waitcnt lgkmcnt(14)
  v_mfma_f32_16x16x32_bf16 v[100:103], v[140:143], v[216:219], v[100:103]
  v_mfma_f32_16x16x32_bf16 v[104:107], v[144:147], v[216:219], v[104:107]
  s_waitcnt lgkmcnt(13)
  v_mfma_f32_16x16x32_bf16 v[108:111], v[140:143], v[220:223], v[108:111]
  v_mfma_f32_16x16x32_bf16 v[112:115], v[144:147], v[220:223], v[112:115]
  s_waitcnt lgkmcnt(12)
  v_mfma_f32_16x16x32_bf16 v[116:119], v[140:143], v[224:227], v[116:119]
  v_mfma_f32_16x16x32_bf16 v[120:123], v[144:147], v[224:227], v[120:123]
  s_waitcnt lgkmcnt(9)
  v_mfma_f32_16x16x32_bf16 v[44:47], v[132:135], v[148:151], v[44:47]
  ds_read_b128 v[140:143], v14 offset:0
  v_mfma_f32_16x16x32_bf16 v[48:51], v[136:139], v[148:151], v[48:51]
  ds_read_b128 v[144:147], v14 offset:2048
  s_waitcnt lgkmcnt(10)
  v_mfma_f32_16x16x32_bf16 v[52:55], v[132:135], v[152:155], v[52:55]
  ds_read_b128 v[188:191], v16 offset:10240
  v_mfma_f32_16x16x32_bf16 v[56:59], v[136:139], v[152:155], v[56:59]
  ds_read_b128 v[192:195], v16 offset:11264
  s_waitcnt lgkmcnt(11)
  v_mfma_f32_16x16x32_bf16 v[60:63], v[132:135], v[156:159], v[60:63]
  ds_read_b128 v[196:199], v16 offset:12288
  v_mfma_f32_16x16x32_bf16 v[64:67], v[136:139], v[156:159], v[64:67]
  ds_read_b128 v[200:203], v16 offset:13312
  s_waitcnt lgkmcnt(12)
  v_mfma_f32_16x16x32_bf16 v[68:71], v[132:135], v[160:163], v[68:71]
  ds_read_b128 v[204:207], v16 offset:14336
  v_mfma_f32_16x16x32_bf16 v[72:75], v[136:139], v[160:163], v[72:75]
  ds_read_b128 v[208:211], v16 offset:15360
  s_waitcnt lgkmcnt(13)
  v_mfma_f32_16x16x32_bf16 v[76:79], v[132:135], v[164:167], v[76:79]
  ds_read_b128 v[212:215], v16 offset:16384
  v_mfma_f32_16x16x32_bf16 v[80:83], v[136:139], v[164:167], v[80:83]
  ds_read_b128 v[216:219], v16 offset:17408
  s_waitcnt lgkmcnt(14)
  v_mfma_f32_16x16x32_bf16 v[84:87], v[132:135], v[168:171], v[84:87]
  ds_read_b128 v[220:223], v16 offset:18432
  v_mfma_f32_16x16x32_bf16 v[88:91], v[136:139], v[168:171], v[88:91]
  s_waitcnt lgkmcnt(10)
  ds_read_b128 v[224:227], v16 offset:19456
  v_mfma_f32_16x16x32_bf16 v[92:95], v[132:135], v[172:175], v[92:95]
  v_mfma_f32_16x16x32_bf16 v[96:99], v[136:139], v[172:175], v[96:99]
  v_mfma_f32_16x16x32_bf16 v[100:103], v[132:135], v[176:179], v[100:103]
  v_mfma_f32_16x16x32_bf16 v[104:107], v[136:139], v[176:179], v[104:107]
  v_mfma_f32_16x16x32_bf16 v[108:111], v[132:135], v[180:183], v[108:111]
  v_mfma_f32_16x16x32_bf16 v[112:115], v[136:139], v[180:183], v[112:115]
  v_mfma_f32_16x16x32_bf16 v[116:119], v[132:135], v[184:187], v[116:119]
  v_mfma_f32_16x16x32_bf16 v[120:123], v[136:139], v[184:187], v[120:123]
  s_waitcnt lgkmcnt(9)
  v_mfma_f32_16x16x32_bf16 v[44:47], v[140:143], v[188:191], v[44:47]
  v_mfma_f32_16x16x32_bf16 v[48:51], v[144:147], v[188:191], v[48:51]
  s_barrier
  v_add_u32 v13, 124928, v7
  v_add_u32 v14, 124928, v8
  ds_read_b128 v[132:135], v13 offset:0
  s_waitcnt lgkmcnt(9)
  v_mfma_f32_16x16x32_bf16 v[52:55], v[140:143], v[192:195], v[52:55]
  ds_read_b128 v[136:139], v13 offset:2048
  v_mfma_f32_16x16x32_bf16 v[56:59], v[144:147], v[192:195], v[56:59]
  ds_read_b128 v[148:151], v16 offset:20480
  s_waitcnt lgkmcnt(10)
  v_mfma_f32_16x16x32_bf16 v[60:63], v[140:143], v[196:199], v[60:63]
  ds_read_b128 v[152:155], v16 offset:21504
  v_mfma_f32_16x16x32_bf16 v[64:67], v[144:147], v[196:199], v[64:67]
  ds_read_b128 v[156:159], v16 offset:22528
  s_waitcnt lgkmcnt(11)
  v_mfma_f32_16x16x32_bf16 v[68:71], v[140:143], v[200:203], v[68:71]
  ds_read_b128 v[160:163], v16 offset:23552
  v_mfma_f32_16x16x32_bf16 v[72:75], v[144:147], v[200:203], v[72:75]
  ds_read_b128 v[164:167], v16 offset:24576
  s_waitcnt lgkmcnt(12)
  v_mfma_f32_16x16x32_bf16 v[76:79], v[140:143], v[204:207], v[76:79]
  ds_read_b128 v[168:171], v16 offset:25600
  v_mfma_f32_16x16x32_bf16 v[80:83], v[144:147], v[204:207], v[80:83]
  ds_read_b128 v[172:175], v16 offset:26624
  s_waitcnt lgkmcnt(13)
  v_mfma_f32_16x16x32_bf16 v[84:87], v[140:143], v[208:211], v[84:87]
  ds_read_b128 v[176:179], v16 offset:27648
  v_mfma_f32_16x16x32_bf16 v[88:91], v[144:147], v[208:211], v[88:91]
  ds_read_b128 v[180:183], v16 offset:28672
  s_waitcnt lgkmcnt(14)
  v_mfma_f32_16x16x32_bf16 v[92:95], v[140:143], v[212:215], v[92:95]
  ds_read_b128 v[184:187], v16 offset:29696
  v_mfma_f32_16x16x32_bf16 v[96:99], v[144:147], v[212:215], v[96:99]
  s_waitcnt lgkmcnt(14)
  v_mfma_f32_16x16x32_bf16 v[100:103], v[140:143], v[216:219], v[100:103]
  v_mfma_f32_16x16x32_bf16 v[104:107], v[144:147], v[216:219], v[104:107]
  s_waitcnt lgkmcnt(13)
  v_mfma_f32_16x16x32_bf16 v[108:111], v[140:143], v[220:223], v[108:111]
  v_mfma_f32_16x16x32_bf16 v[112:115], v[144:147], v[220:223], v[112:115]
  s_waitcnt lgkmcnt(12)
  v_mfma_f32_16x16x32_bf16 v[116:119], v[140:143], v[224:227], v[116:119]
  v_mfma_f32_16x16x32_bf16 v[120:123], v[144:147], v[224:227], v[120:123]
  s_waitcnt lgkmcnt(9)
  v_mfma_f32_16x16x32_bf16 v[44:47], v[132:135], v[148:151], v[44:47]
  ds_read_b128 v[140:143], v14 offset:0
  v_mfma_f32_16x16x32_bf16 v[48:51], v[136:139], v[148:151], v[48:51]
  ds_read_b128 v[144:147], v14 offset:2048
  s_waitcnt lgkmcnt(10)
  v_mfma_f32_16x16x32_bf16 v[52:55], v[132:135], v[152:155], v[52:55]
  ds_read_b128 v[188:191], v16 offset:30720
  v_mfma_f32_16x16x32_bf16 v[56:59], v[136:139], v[152:155], v[56:59]
  ds_read_b128 v[192:195], v16 offset:31744
  s_waitcnt lgkmcnt(11)
  v_mfma_f32_16x16x32_bf16 v[60:63], v[132:135], v[156:159], v[60:63]
  ds_read_b128 v[196:199], v16 offset:32768
  v_mfma_f32_16x16x32_bf16 v[64:67], v[136:139], v[156:159], v[64:67]
  ds_read_b128 v[200:203], v16 offset:33792
  s_waitcnt lgkmcnt(12)
  v_mfma_f32_16x16x32_bf16 v[68:71], v[132:135], v[160:163], v[68:71]
  ds_read_b128 v[204:207], v16 offset:34816
  v_mfma_f32_16x16x32_bf16 v[72:75], v[136:139], v[160:163], v[72:75]
  ds_read_b128 v[208:211], v16 offset:35840
  s_waitcnt lgkmcnt(13)
  v_mfma_f32_16x16x32_bf16 v[76:79], v[132:135], v[164:167], v[76:79]
  ds_read_b128 v[212:215], v16 offset:36864
  v_mfma_f32_16x16x32_bf16 v[80:83], v[136:139], v[164:167], v[80:83]
  ds_read_b128 v[216:219], v16 offset:37888
  s_waitcnt lgkmcnt(14)
  v_mfma_f32_16x16x32_bf16 v[84:87], v[132:135], v[168:171], v[84:87]
  ds_read_b128 v[220:223], v16 offset:38912
  v_mfma_f32_16x16x32_bf16 v[88:91], v[136:139], v[168:171], v[88:91]
  s_waitcnt lgkmcnt(10)
  ds_read_b128 v[224:227], v16 offset:39936
  v_mfma_f32_16x16x32_bf16 v[92:95], v[132:135], v[172:175], v[92:95]
  v_mfma_f32_16x16x32_bf16 v[96:99], v[136:139], v[172:175], v[96:99]
  v_mfma_f32_16x16x32_bf16 v[100:103], v[132:135], v[176:179], v[100:103]
  v_mfma_f32_16x16x32_bf16 v[104:107], v[136:139], v[176:179], v[104:107]
  v_mfma_f32_16x16x32_bf16 v[108:111], v[132:135], v[180:183], v[108:111]
  v_mfma_f32_16x16x32_bf16 v[112:115], v[136:139], v[180:183], v[112:115]
  v_mfma_f32_16x16x32_bf16 v[116:119], v[132:135], v[184:187], v[116:119]
  v_mfma_f32_16x16x32_bf16 v[120:123], v[136:139], v[184:187], v[120:123]
  s_waitcnt lgkmcnt(9)
  v_mfma_f32_16x16x32_bf16 v[44:47], v[140:143], v[188:191], v[44:47]
  v_mfma_f32_16x16x32_bf16 v[48:51], v[144:147], v[188:191], v[48:51]
  s_waitcnt lgkmcnt(8)
  v_mfma_f32_16x16x32_bf16 v[52:55], v[140:143], v[192:195], v[52:55]
  v_mfma_f32_16x16x32_bf16 v[56:59], v[144:147], v[192:195], v[56:59]
  s_waitcnt lgkmcnt(7)
  v_mfma_f32_16x16x32_bf16 v[60:63], v[140:143], v[196:199], v[60:63]
  v_mfma_f32_16x16x32_bf16 v[64:67], v[144:147], v[196:199], v[64:67]
  s_waitcnt lgkmcnt(6)
  v_mfma_f32_16x16x32_bf16 v[68:71], v[140:143], v[200:203], v[68:71]
  v_mfma_f32_16x16x32_bf16 v[72:75], v[144:147], v[200:203], v[72:75]
  s_waitcnt lgkmcnt(5)
  v_mfma_f32_16x16x32_bf16 v[76:79], v[140:143], v[204:207], v[76:79]
  v_mfma_f32_16x16x32_bf16 v[80:83], v[144:147], v[204:207], v[80:83]
  s_waitcnt lgkmcnt(4)
  v_mfma_f32_16x16x32_bf16 v[84:87], v[140:143], v[208:211], v[84:87]
  v_mfma_f32_16x16x32_bf16 v[88:91], v[144:147], v[208:211], v[88:91]
  s_waitcnt lgkmcnt(3)
  v_mfma_f32_16x16x32_bf16 v[92:95], v[140:143], v[212:215], v[92:95]
  v_mfma_f32_16x16x32_bf16 v[96:99], v[144:147], v[212:215], v[96:99]
  s_waitcnt lgkmcnt(2)
  v_mfma_f32_16x16x32_bf16 v[100:103], v[140:143], v[216:219], v[100:103]
  v_mfma_f32_16x16x32_bf16 v[104:107], v[144:147], v[216:219], v[104:107]
  s_waitcnt lgkmcnt(1)
  v_mfma_f32_16x16x32_bf16 v[108:111], v[140:143], v[220:223], v[108:111]
  v_mfma_f32_16x16x32_bf16 v[112:115], v[144:147], v[220:223], v[112:115]
  s_waitcnt lgkmcnt(0)
  v_mfma_f32_16x16x32_bf16 v[116:119], v[140:143], v[224:227], v[116:119]
  v_mfma_f32_16x16x32_bf16 v[120:123], v[144:147], v[224:227], v[120:123]
  s_barrier
  v_cvt_pk_bf16_f32 v132, v44, v45
  v_cvt_pk_bf16_f32 v133, v46, v47
  v_cvt_pk_bf16_f32 v134, v48, v49
  v_cvt_pk_bf16_f32 v135, v50, v51
  v_cvt_pk_bf16_f32 v152, v84, v85
  v_cvt_pk_bf16_f32 v153, v86, v87
  v_cvt_pk_bf16_f32 v154, v88, v89
  v_cvt_pk_bf16_f32 v155, v90, v91
  v_mfma_f32_16x16x32_bf16 v[172:175], v[20:23], v[132:135], 0
  v_cvt_pk_bf16_f32 v136, v52, v53
  v_mfma_f32_16x16x32_bf16 v[176:179], v[36:39], v[132:135], 0
  v_cvt_pk_bf16_f32 v137, v54, v55
  v_mfma_f32_16x16x32_bf16 v[180:183], v[24:27], v[132:135], 0
  v_cvt_pk_bf16_f32 v138, v56, v57
  v_mfma_f32_16x16x32_bf16 v[184:187], v[40:43], v[132:135], 0
  v_cvt_pk_bf16_f32 v139, v58, v59
  v_mfma_f32_16x16x32_bf16 v[172:175], v[28:31], v[152:155], v[172:175]
  v_cvt_pk_bf16_f32 v156, v92, v93
  v_mfma_f32_16x16x32_bf16 v[176:179], v[20:23], v[152:155], v[176:179]
  v_cvt_pk_bf16_f32 v157, v94, v95
  v_mfma_f32_16x16x32_bf16 v[180:183], v[32:35], v[152:155], v[180:183]
  v_cvt_pk_bf16_f32 v158, v96, v97
  v_mfma_f32_16x16x32_bf16 v[184:187], v[24:27], v[152:155], v[184:187]
  v_cvt_pk_bf16_f32 v159, v98, v99
  v_mfma_f32_16x16x32_bf16 v[188:191], v[20:23], v[136:139], 0
  v_cvt_pk_bf16_f32 v140, v60, v61
  v_mfma_f32_16x16x32_bf16 v[192:195], v[36:39], v[136:139], 0
  v_cvt_pk_bf16_f32 v141, v62, v63
  v_mfma_f32_16x16x32_bf16 v[196:199], v[24:27], v[136:139], 0
  v_cvt_pk_bf16_f32 v142, v64, v65
  v_mfma_f32_16x16x32_bf16 v[200:203], v[40:43], v[136:139], 0
  v_cvt_pk_bf16_f32 v143, v66, v67
  v_mfma_f32_16x16x32_bf16 v[188:191], v[28:31], v[156:159], v[188:191]
  v_cvt_pk_bf16_f32 v160, v100, v101
  v_mfma_f32_16x16x32_bf16 v[192:195], v[20:23], v[156:159], v[192:195]
  v_cvt_pk_bf16_f32 v161, v102, v103
  v_mfma_f32_16x16x32_bf16 v[196:199], v[32:35], v[156:159], v[196:199]
  v_cvt_pk_bf16_f32 v162, v104, v105
  v_mfma_f32_16x16x32_bf16 v[200:203], v[24:27], v[156:159], v[200:203]
  v_cvt_pk_bf16_f32 v163, v106, v107
  s_waitcnt lgkmcnt(6)
  v_mfma_f32_16x16x32_bf16 v[204:207], v[20:23], v[140:143], 0
  v_cvt_pk_bf16_f32 v144, v68, v69
  v_cvt_pk_bf16_f32 v44, v172, v176
  ds_write_b32 v129, v44 offset:0
  v_mfma_f32_16x16x32_bf16 v[208:211], v[36:39], v[140:143], 0
  v_cvt_pk_bf16_f32 v145, v70, v71
  v_cvt_pk_bf16_f32 v45, v173, v177
  ds_write_b32 v129, v45 offset:320
  v_mfma_f32_16x16x32_bf16 v[212:215], v[24:27], v[140:143], 0
  v_cvt_pk_bf16_f32 v146, v72, v73
  v_cvt_pk_bf16_f32 v46, v174, v178
  ds_write_b32 v129, v46 offset:640
  v_mfma_f32_16x16x32_bf16 v[216:219], v[40:43], v[140:143], 0
  v_cvt_pk_bf16_f32 v147, v74, v75
  v_cvt_pk_bf16_f32 v47, v175, v179
  ds_write_b32 v129, v47 offset:960
  v_mfma_f32_16x16x32_bf16 v[204:207], v[28:31], v[160:163], v[204:207]
  v_cvt_pk_bf16_f32 v164, v108, v109
  v_cvt_pk_bf16_f32 v48, v180, v184
  ds_write_b32 v129, v48 offset:5120
  v_mfma_f32_16x16x32_bf16 v[208:211], v[20:23], v[160:163], v[208:211]
  v_cvt_pk_bf16_f32 v165, v110, v111
  v_cvt_pk_bf16_f32 v49, v181, v185
  ds_write_b32 v129, v49 offset:5440
  v_mfma_f32_16x16x32_bf16 v[212:215], v[32:35], v[160:163], v[212:215]
  v_cvt_pk_bf16_f32 v166, v112, v113
  v_cvt_pk_bf16_f32 v50, v182, v186
  ds_write_b32 v129, v50 offset:5760
  v_mfma_f32_16x16x32_bf16 v[216:219], v[24:27], v[160:163], v[216:219]
  v_cvt_pk_bf16_f32 v167, v114, v115
  v_cvt_pk_bf16_f32 v51, v183, v187
  ds_write_b32 v129, v51 offset:6080
  s_waitcnt lgkmcnt(6)
  v_mfma_f32_16x16x32_bf16 v[172:175], v[20:23], v[144:147], 0
  v_cvt_pk_bf16_f32 v148, v76, v77
  v_cvt_pk_bf16_f32 v52, v188, v192
  ds_write_b32 v129, v52 offset:64
  v_mfma_f32_16x16x32_bf16 v[176:179], v[36:39], v[144:147], 0
  v_cvt_pk_bf16_f32 v149, v78, v79
  v_cvt_pk_bf16_f32 v53, v189, v193
  ds_write_b32 v129, v53 offset:384
  v_mfma_f32_16x16x32_bf16 v[180:183], v[24:27], v[144:147], 0
  v_cvt_pk_bf16_f32 v150, v80, v81
  v_cvt_pk_bf16_f32 v54, v190, v194
  ds_write_b32 v129, v54 offset:704
  v_mfma_f32_16x16x32_bf16 v[184:187], v[40:43], v[144:147], 0
  v_cvt_pk_bf16_f32 v151, v82, v83
  v_cvt_pk_bf16_f32 v55, v191, v195
  ds_write_b32 v129, v55 offset:1024
  v_mfma_f32_16x16x32_bf16 v[172:175], v[28:31], v[164:167], v[172:175]
  v_cvt_pk_bf16_f32 v168, v116, v117
  v_cvt_pk_bf16_f32 v56, v196, v200
  ds_write_b32 v129, v56 offset:5184
  v_mfma_f32_16x16x32_bf16 v[176:179], v[20:23], v[164:167], v[176:179]
  v_cvt_pk_bf16_f32 v169, v118, v119
  v_cvt_pk_bf16_f32 v57, v197, v201
  ds_write_b32 v129, v57 offset:5504
  v_mfma_f32_16x16x32_bf16 v[180:183], v[32:35], v[164:167], v[180:183]
  v_cvt_pk_bf16_f32 v170, v120, v121
  v_cvt_pk_bf16_f32 v58, v198, v202
  ds_write_b32 v129, v58 offset:5824
  v_mfma_f32_16x16x32_bf16 v[184:187], v[24:27], v[164:167], v[184:187]
  v_cvt_pk_bf16_f32 v171, v122, v123
  v_cvt_pk_bf16_f32 v59, v199, v203
  ds_write_b32 v129, v59 offset:6144
  s_waitcnt lgkmcnt(6)
  v_mfma_f32_16x16x32_bf16 v[188:191], v[20:23], v[148:151], 0
  v_cvt_pk_bf16_f32 v60, v204, v208
  ds_write_b32 v129, v60 offset:128
  v_mfma_f32_16x16x32_bf16 v[192:195], v[36:39], v[148:151], 0
  v_cvt_pk_bf16_f32 v61, v205, v209
  ds_write_b32 v129, v61 offset:448
  v_mfma_f32_16x16x32_bf16 v[196:199], v[24:27], v[148:151], 0
  v_cvt_pk_bf16_f32 v62, v206, v210
  ds_write_b32 v129, v62 offset:768
  v_mfma_f32_16x16x32_bf16 v[200:203], v[40:43], v[148:151], 0
  v_cvt_pk_bf16_f32 v63, v207, v211
  ds_write_b32 v129, v63 offset:1088
  v_mfma_f32_16x16x32_bf16 v[188:191], v[28:31], v[168:171], v[188:191]
  v_cvt_pk_bf16_f32 v64, v212, v216
  ds_write_b32 v129, v64 offset:5248
  v_mfma_f32_16x16x32_bf16 v[192:195], v[20:23], v[168:171], v[192:195]
  v_cvt_pk_bf16_f32 v65, v213, v217
  ds_write_b32 v129, v65 offset:5568
  v_mfma_f32_16x16x32_bf16 v[196:199], v[32:35], v[168:171], v[196:199]
  v_cvt_pk_bf16_f32 v66, v214, v218
  ds_write_b32 v129, v66 offset:5888
  v_mfma_f32_16x16x32_bf16 v[200:203], v[24:27], v[168:171], v[200:203]
  v_cvt_pk_bf16_f32 v67, v215, v219
  ds_write_b32 v129, v67 offset:6208
  s_waitcnt lgkmcnt(6)
  v_cvt_pk_bf16_f32 v68, v172, v176
  ds_write_b32 v129, v68 offset:192
  v_cvt_pk_bf16_f32 v69, v173, v177
  ds_write_b32 v129, v69 offset:512
  v_cvt_pk_bf16_f32 v70, v174, v178
  ds_write_b32 v129, v70 offset:832
  v_cvt_pk_bf16_f32 v71, v175, v179
  ds_write_b32 v129, v71 offset:1152
  v_cvt_pk_bf16_f32 v72, v180, v184
  ds_write_b32 v129, v72 offset:5312
  v_cvt_pk_bf16_f32 v73, v181, v185
  ds_write_b32 v129, v73 offset:5632
  v_cvt_pk_bf16_f32 v74, v182, v186
  ds_write_b32 v129, v74 offset:5952
  v_cvt_pk_bf16_f32 v75, v183, v187
  ds_write_b32 v129, v75 offset:6272
  s_waitcnt lgkmcnt(6)
  v_cvt_pk_bf16_f32 v76, v188, v192
  ds_write_b32 v129, v76 offset:256
  v_cvt_pk_bf16_f32 v77, v189, v193
  ds_write_b32 v129, v77 offset:576
  v_cvt_pk_bf16_f32 v78, v190, v194
  ds_write_b32 v129, v78 offset:896
  v_cvt_pk_bf16_f32 v79, v191, v195
  ds_write_b32 v129, v79 offset:1216
  v_cvt_pk_bf16_f32 v80, v196, v200
  ds_write_b32 v129, v80 offset:5376
  v_cvt_pk_bf16_f32 v81, v197, v201
  ds_write_b32 v129, v81 offset:5696
  v_cvt_pk_bf16_f32 v82, v198, v202
  ds_write_b32 v129, v82 offset:6016
  v_cvt_pk_bf16_f32 v83, v199, v203
  ds_write_b32 v129, v83 offset:6336
  s_waitcnt lgkmcnt(0)
  s_barrier
  ds_read2st64_b32 v[44:45], v128 offset0:0 offset1:40
  ds_read2st64_b32 v[46:47], v128 offset0:80 offset1:120
  ds_read2st64_b32 v[48:49], v128 offset0:8 offset1:48
  ds_read2st64_b32 v[50:51], v128 offset0:88 offset1:128
  ds_read2st64_b32 v[52:53], v128 offset0:16 offset1:56
  ds_read2st64_b32 v[54:55], v128 offset0:96 offset1:136
  ds_read2st64_b32 v[56:57], v128 offset0:24 offset1:64
  ds_read2st64_b32 v[58:59], v128 offset0:104 offset1:144
  ds_read2st64_b32 v[60:61], v128 offset0:32 offset1:72
  ds_read2st64_b32 v[62:63], v128 offset0:112 offset1:152
  s_waitcnt lgkmcnt(8)
  buffer_store_dwordx4 v[44:47], v17, s[32:35], s55 offen sc1
  s_waitcnt lgkmcnt(6)
  buffer_store_dwordx4 v[48:51], v124, s[32:35], s55 offen sc1
  s_waitcnt lgkmcnt(4)
  buffer_store_dwordx4 v[52:55], v125, s[32:35], s55 offen sc1
  s_waitcnt lgkmcnt(2)
  buffer_store_dwordx4 v[56:59], v126, s[32:35], s55 offen sc1
  s_waitcnt lgkmcnt(0)
  buffer_store_dwordx4 v[60:63], v127, s[32:35], s55 offen sc1
  v_and_b32 v11, 15, v1
  s_lshl_b32 s48, s44, 4
  v_add_u32 v11, s48, v11
  v_lshrrev_b32 v12, 4, v1
  v_lshlrev_b32 v12, 2, v12
  s_add_u32 s48, s64, 147456
  v_lshl_add_u32 v2, v1, 4, s48
  v_add_u32 v4, 0, v12
  v_mul_u32_u24 v4, v4, v11
  v_and_b32 v4, 63, v4
  v_cvt_f32_u32 v4, v4
  v_mul_f32 v4, 0x3c800000, v4
  v_cos_f32 v9, v4
  v_sin_f32 v10, v4
  s_nop 0
  v_cvt_pk_bf16_f32 v20, v9, v10
  v_add_u32 v4, 1, v12
  v_mul_u32_u24 v4, v4, v11
  v_and_b32 v4, 63, v4
  v_cvt_f32_u32 v4, v4
  v_mul_f32 v4, 0x3c800000, v4
  v_cos_f32 v9, v4
  v_sin_f32 v10, v4
  s_nop 0
  v_cvt_pk_bf16_f32 v21, v9, v10
  v_add_u32 v4, 2, v12
  v_mul_u32_u24 v4, v4, v11
  v_and_b32 v4, 63, v4
  v_cvt_f32_u32 v4, v4
  v_mul_f32 v4, 0x3c800000, v4
  v_cos_f32 v9, v4
  v_sin_f32 v10, v4
  s_nop 0
  v_cvt_pk_bf16_f32 v22, v9, v10
  v_add_u32 v4, 3, v12
  v_mul_u32_u24 v4, v4, v11
  v_and_b32 v4, 63, v4
  v_cvt_f32_u32 v4, v4
  v_mul_f32 v4, 0x3c800000, v4
  v_cos_f32 v9, v4
  v_sin_f32 v10, v4
  s_nop 0
  v_cvt_pk_bf16_f32 v23, v9, v10
  ds_write_b128 v2, v[20:23] offset:0
  s_waitcnt lgkmcnt(0)
  v_add_u32 v4, 16, v12
  v_mul_u32_u24 v4, v4, v11
  v_and_b32 v4, 63, v4
  v_cvt_f32_u32 v4, v4
  v_mul_f32 v4, 0x3c800000, v4
  v_cos_f32 v9, v4
  v_sin_f32 v10, v4
  s_nop 0
  v_cvt_pk_bf16_f32 v20, v9, v10
  v_add_u32 v4, 17, v12
  v_mul_u32_u24 v4, v4, v11
  v_and_b32 v4, 63, v4
  v_cvt_f32_u32 v4, v4
  v_mul_f32 v4, 0x3c800000, v4
  v_cos_f32 v9, v4
  v_sin_f32 v10, v4
  s_nop 0
  v_cvt_pk_bf16_f32 v21, v9, v10
  v_add_u32 v4, 18, v12
  v_mul_u32_u24 v4, v4, v11
  v_and_b32 v4, 63, v4
  v_cvt_f32_u32 v4, v4
  v_mul_f32 v4, 0x3c800000, v4
  v_cos_f32 v9, v4
  v_sin_f32 v10, v4
  s_nop 0
  v_cvt_pk_bf16_f32 v22, v9, v10
  v_add_u32 v4, 19, v12
  v_mul_u32_u24 v4, v4, v11
  v_and_b32 v4, 63, v4
  v_cvt_f32_u32 v4, v4
  v_mul_f32 v4, 0x3c800000, v4
  v_cos_f32 v9, v4
  v_sin_f32 v10, v4
  s_nop 0
  v_cvt_pk_bf16_f32 v23, v9, v10
  ds_write_b128 v2, v[20:23] offset:1024
  s_waitcnt lgkmcnt(0)
  v_add_u32 v4, 32, v12
  v_mul_u32_u24 v4, v4, v11
  v_and_b32 v4, 63, v4
  v_cvt_f32_u32 v4, v4
  v_mul_f32 v4, 0x3c800000, v4
  v_cos_f32 v9, v4
  v_sin_f32 v10, v4
  s_nop 0
  v_cvt_pk_bf16_f32 v20, v9, v10
  v_add_u32 v4, 33, v12
  v_mul_u32_u24 v4, v4, v11
  v_and_b32 v4, 63, v4
  v_cvt_f32_u32 v4, v4
  v_mul_f32 v4, 0x3c800000, v4
  v_cos_f32 v9, v4
  v_sin_f32 v10, v4
  s_nop 0
  v_cvt_pk_bf16_f32 v21, v9, v10
  v_add_u32 v4, 34, v12
  v_mul_u32_u24 v4, v4, v11
  v_and_b32 v4, 63, v4
  v_cvt_f32_u32 v4, v4
  v_mul_f32 v4, 0x3c800000, v4
  v_cos_f32 v9, v4
  v_sin_f32 v10, v4
  s_nop 0
  v_cvt_pk_bf16_f32 v22, v9, v10
  v_add_u32 v4, 35, v12
  v_mul_u32_u24 v4, v4, v11
  v_and_b32 v4, 63, v4
  v_cvt_f32_u32 v4, v4
  v_mul_f32 v4, 0x3c800000, v4
  v_cos_f32 v9, v4
  v_sin_f32 v10, v4
  s_nop 0
  v_cvt_pk_bf16_f32 v23, v9, v10
  ds_write_b128 v2, v[20:23] offset:2048
  s_waitcnt lgkmcnt(0)
  v_add_u32 v4, 48, v12
  v_mul_u32_u24 v4, v4, v11
  v_and_b32 v4, 63, v4
  v_cvt_f32_u32 v4, v4
  v_mul_f32 v4, 0x3c800000, v4
  v_cos_f32 v9, v4
  v_sin_f32 v10, v4
  s_nop 0
  v_cvt_pk_bf16_f32 v20, v9, v10
  v_add_u32 v4, 49, v12
  v_mul_u32_u24 v4, v4, v11
  v_and_b32 v4, 63, v4
  v_cvt_f32_u32 v4, v4
  v_mul_f32 v4, 0x3c800000, v4
  v_cos_f32 v9, v4
  v_sin_f32 v10, v4
  s_nop 0
  v_cvt_pk_bf16_f32 v21, v9, v10
  v_add_u32 v4, 50, v12
  v_mul_u32_u24 v4, v4, v11
  v_and_b32 v4, 63, v4
  v_cvt_f32_u32 v4, v4
  v_mul_f32 v4, 0x3c800000, v4
  v_cos_f32 v9, v4
  v_sin_f32 v10, v4
  s_nop 0
  v_cvt_pk_bf16_f32 v22, v9, v10
  v_add_u32 v4, 51, v12
  v_mul_u32_u24 v4, v4, v11
  v_and_b32 v4, 63, v4
  v_cvt_f32_u32 v4, v4
  v_mul_f32 v4, 0x3c800000, v4
  v_cos_f32 v9, v4
  v_sin_f32 v10, v4
  s_nop 0
  v_cvt_pk_bf16_f32 v23, v9, v10
  ds_write_b128 v2, v[20:23] offset:3072
  s_waitcnt lgkmcnt(0)
  s_waitcnt vmcnt(0) lgkmcnt(0)
  s_barrier
  s_mul_i32 s49, s67, 72
  s_cmp_ge_u32 s67, 4
  s_cselect_b32 s50, -16, 16
  s_cselect_b32 s51, 9216, 0
  s_mul_i32 s49, s49, s50
  s_add_u32 s49, s49, s51
  v_lshrrev_b32 v2, 4, v1
  v_mul_u32_u24 v2, 5120, v2
  v_add_u32 v2, s49, v2
  v_and_b32 v3, 15, v1
  v_mul_lo_u32 v4, v3, s50
  v_add_u32 v7, v2, v4
  s_lshl_b32 s50, s50, 4
  v_add_u32 v8, s50, v7
  v_add_u32 v13, s50, v8
  v_add_u32 v14, s50, v13
  v_add_u32 v15, s50, v14
  v_mov_b32 v5, 1073741824
  v_cmp_gt_u32 vcc, 8, v3
  s_nop 1
  v_cndmask_b32 v15, v5, v15, vcc
  s_lshl_b32 s54, s45, 2
  s_add_u32 s54, s54, s44
  s_mul_i32 s53, s54, 81920
  s_add_u32 s53, s53, 6815744
  s_cmp_ge_u32 s67, 4
  s_cselect_b32 s50, -1, 1
  v_bfe_u32 v4, v1, 4, 1
  v_lshlrev_b32 v4, 5, v4
  v_lshrrev_b32 v9, 5, v1
  v_lshl_add_u32 v4, v9, 4, v4
  v_lshrrev_b32 v9, 4, v1
  v_cmp_gt_u32 vcc, 2, v9
  v_lshlrev_b32 v9, 3, v9
  s_nop 0
  v_cndmask_b32 v9, v5, v9, vcc
  s_add_u32 s49, s54, 0
  v_lshl_add_u32 v2, v3, 5, s49
  v_mul_lo_u32 v2, v2, s50
  v_and_b32 v2, 2047, v2
  v_mul_u32_u24 v2, 2304, v2
  v_add_u32 v16, v2, v4
  v_add_u32 v21, v2, v9
  s_add_u32 s49, s54, 512
  v_lshl_add_u32 v2, v3, 5, s49
  v_mul_lo_u32 v2, v2, s50
  v_and_b32 v2, 2047, v2
  v_mul_u32_u24 v2, 2304, v2
  v_add_u32 v18, v2, v4
  v_add_u32 v22, v2, v9
  s_add_u32 s49, s54, 1024
  v_lshl_add_u32 v2, v3, 5, s49
  v_mul_lo_u32 v2, v2, s50
  v_and_b32 v2, 2047, v2
  v_mul_u32_u24 v2, 2304, v2
  v_add_u32 v19, v2, v4
  v_add_u32 v23, v2, v9
  s_add_u32 s49, s54, 1536
  v_lshl_add_u32 v2, v3, 5, s49
  v_mul_lo_u32 v2, v2, s50
  v_and_b32 v2, 2047, v2
  v_mul_u32_u24 v2, 2304, v2
  v_add_u32 v20, v2, v4
  v_add_u32 v24, v2, v9
  s_mul_i32 s52, s67, 144
  s_add_u32 s52, s52, 1152
  v_lshlrev_b32 v2, 4, v1
  v_add_u32 v2, 147456, v2
  ds_read_b128 v[132:135], v2 offset:0
  ds_read_b128 v[136:139], v2 offset:1024
  ds_read_b128 v[140:143], v2 offset:2048
  ds_read_b128 v[144:147], v2 offset:3072
  ds_read_b128 v[148:151], v2 offset:4096
  ds_read_b128 v[152:155], v2 offset:5120
  ds_read_b128 v[156:159], v2 offset:6144
  ds_read_b128 v[160:163], v2 offset:7168
  s_waitcnt lgkmcnt(0)
  ds_read_b128 v[164:167], v2 offset:8192
  ds_read_b128 v[168:171], v2 offset:9216
  ds_read_b128 v[172:175], v2 offset:10240
  ds_read_b128 v[176:179], v2 offset:11264
  ds_read_b128 v[180:183], v2 offset:12288
  ds_read_b128 v[184:187], v2 offset:13312
  ds_read_b128 v[188:191], v2 offset:14336
  ds_read_b128 v[192:195], v2 offset:15360
  s_waitcnt lgkmcnt(0)
  s_barrier
  s_add_u32 s48, s53, 0
  buffer_load_dwordx4 v[44:47], v7, s[32:35], s48 offen sc1
  s_add_u32 s48, s53, 20480
  buffer_load_dwordx4 v[48:51], v7, s[32:35], s48 offen sc1
  s_add_u32 s48, s53, 40960
  buffer_load_dwordx4 v[52:55], v7, s[32:35], s48 offen sc1
  s_add_u32 s48, s53, 61440
  buffer_load_dwordx4 v[56:59], v7, s[32:35], s48 offen sc1
  s_add_u32 s48, s53, 0
  buffer_load_dwordx4 v[60:63], v8, s[32:35], s48 offen sc1
  s_add_u32 s48, s53, 20480
  buffer_load_dwordx4 v[64:67], v8, s[32:35], s48 offen sc1
  s_add_u32 s48, s53, 40960
  buffer_load_dwordx4 v[68:71], v8, s[32:35], s48 offen sc1
  s_add_u32 s48, s53, 61440
  buffer_load_dwordx4 v[72:75], v8, s[32:35], s48 offen sc1
  s_add_u32 s48, s53, 0
  buffer_load_dwordx4 v[76:79], v13, s[32:35], s48 offen sc1
  s_add_u32 s48, s53, 20480
  buffer_load_dwordx4 v[80:83], v13, s[32:35], s48 offen sc1
  s_add_u32 s48, s53, 40960
  buffer_load_dwordx4 v[84:87], v13, s[32:35], s48 offen sc1
  s_add_u32 s48, s53, 61440
  buffer_load_dwordx4 v[88:91], v13, s[32:35], s48 offen sc1
  s_add_u32 s48, s53, 0
  buffer_load_dwordx4 v[92:95], v14, s[32:35], s48 offen sc1
  s_add_u32 s48, s53, 20480
  buffer_load_dwordx4 v[96:99], v14, s[32:35], s48 offen sc1
  s_add_u32 s48, s53, 40960
  buffer_load_dwordx4 v[100:103], v14, s[32:35], s48 offen sc1
  s_add_u32 s48, s53, 61440
  buffer_load_dwordx4 v[104:107], v14, s[32:35], s48 offen sc1
  s_add_u32 s48, s53, 0
  buffer_load_dwordx4 v[108:111], v15, s[32:35], s48 offen sc1
  s_add_u32 s48, s53, 20480
  buffer_load_dwordx4 v[112:115], v15, s[32:35], s48 offen sc1
  s_add_u32 s48, s53, 40960
  buffer_load_dwordx4 v[116:119], v15, s[32:35], s48 offen sc1
  s_add_u32 s48, s53, 61440
  buffer_load_dwordx4 v[120:123], v15, s[32:35], s48 offen sc1
  s_waitcnt vmcnt(19)
  v_mfma_f32_16x16x32_bf16 v[196:199], v[44:47], v[132:135], 0
  v_mfma_f32_16x16x32_bf16 v[200:203], v[44:47], v[148:151], 0
  v_mfma_f32_16x16x32_bf16 v[204:207], v[44:47], v[164:167], 0
  v_mfma_f32_16x16x32_bf16 v[208:211], v[44:47], v[180:183], 0
  s_waitcnt vmcnt(18)
  v_mfma_f32_16x16x32_bf16 v[196:199], v[48:51], v[136:139], v[196:199]
  v_mfma_f32_16x16x32_bf16 v[200:203], v[48:51], v[152:155], v[200:203]
  v_mfma_f32_16x16x32_bf16 v[204:207], v[48:51], v[168:171], v[204:207]
  v_mfma_f32_16x16x32_bf16 v[208:211], v[48:51], v[184:187], v[208:211]
  s_waitcnt vmcnt(17)
  v_mfma_f32_16x16x32_bf16 v[196:199], v[52:55], v[140:143], v[196:199]
  v_mfma_f32_16x16x32_bf16 v[200:203], v[52:55], v[156:159], v[200:203]
  v_mfma_f32_16x16x32_bf16 v[204:207], v[52:55], v[172:175], v[204:207]
  v_mfma_f32_16x16x32_bf16 v[208:211], v[52:55], v[188:191], v[208:211]
  s_waitcnt vmcnt(16)
  v_mfma_f32_16x16x32_bf16 v[196:199], v[56:59], v[144:147], v[196:199]
  v_mfma_f32_16x16x32_bf16 v[200:203], v[56:59], v[160:163], v[200:203]
  v_mfma_f32_16x16x32_bf16 v[204:207], v[56:59], v[176:179], v[204:207]
  v_mfma_f32_16x16x32_bf16 v[208:211], v[56:59], v[192:195], v[208:211]
  s_waitcnt vmcnt(15)
  v_mfma_f32_16x16x32_bf16 v[212:215], v[60:63], v[132:135], 0
  s_nop 0
  v_mfma_f32_16x16x32_bf16 v[216:219], v[60:63], v[148:151], 0
  s_nop 0
  v_mfma_f32_16x16x32_bf16 v[220:223], v[60:63], v[164:167], 0
  v_cvt_pk_bf16_f32 v44, v196, v197
  v_mfma_f32_16x16x32_bf16 v[224:227], v[60:63], v[180:183], 0
  v_cvt_pk_bf16_f32 v45, v198, v199
  s_waitcnt vmcnt(14)
  v_mfma_f32_16x16x32_bf16 v[212:215], v[64:67], v[136:139], v[212:215]
  v_cvt_pk_bf16_f32 v48, v200, v201
  v_mfma_f32_16x16x32_bf16 v[216:219], v[64:67], v[152:155], v[216:219]
  v_cvt_pk_bf16_f32 v49, v202, v203
  v_mfma_f32_16x16x32_bf16 v[220:223], v[64:67], v[168:171], v[220:223]
  v_cvt_pk_bf16_f32 v52, v204, v205
  v_mfma_f32_16x16x32_bf16 v[224:227], v[64:67], v[184:187], v[224:227]
  v_cvt_pk_bf16_f32 v53, v206, v207
  s_waitcnt vmcnt(13)
  v_mfma_f32_16x16x32_bf16 v[212:215], v[68:71], v[140:143], v[212:215]
  v_cvt_pk_bf16_f32 v56, v208, v209
  v_mfma_f32_16x16x32_bf16 v[216:219], v[68:71], v[156:159], v[216:219]
  v_cvt_pk_bf16_f32 v57, v210, v211
  v_mfma_f32_16x16x32_bf16 v[220:223], v[68:71], v[172:175], v[220:223]
  v_mfma_f32_16x16x32_bf16 v[224:227], v[68:71], v[188:191], v[224:227]
  s_waitcnt vmcnt(12)
  v_mfma_f32_16x16x32_bf16 v[212:215], v[72:75], v[144:147], v[212:215]
  v_mfma_f32_16x16x32_bf16 v[216:219], v[72:75], v[160:163], v[216:219]
  v_mfma_f32_16x16x32_bf16 v[220:223], v[72:75], v[176:179], v[220:223]
  v_mfma_f32_16x16x32_bf16 v[224:227], v[72:75], v[192:195], v[224:227]
  s_waitcnt vmcnt(11)
  v_mfma_f32_16x16x32_bf16 v[28:31], v[76:79], v[132:135], 0
  s_nop 0
  v_mfma_f32_16x16x32_bf16 v[32:35], v[76:79], v[148:151], 0
  s_nop 0
  v_mfma_f32_16x16x32_bf16 v[36:39], v[76:79], v[164:167], 0
  v_cvt_pk_bf16_f32 v46, v212, v213
  v_mfma_f32_16x16x32_bf16 v[40:43], v[76:79], v[180:183], 0
  v_cvt_pk_bf16_f32 v47, v214, v215
  s_waitcnt vmcnt(10)
  v_mfma_f32_16x16x32_bf16 v[28:31], v[80:83], v[136:139], v[28:31]
  v_cvt_pk_bf16_f32 v50, v216, v217
  v_mfma_f32_16x16x32_bf16 v[32:35], v[80:83], v[152:155], v[32:35]
  v_cvt_pk_bf16_f32 v51, v218, v219
  v_mfma_f32_16x16x32_bf16 v[36:39], v[80:83], v[168:171], v[36:39]
  v_cvt_pk_bf16_f32 v54, v220, v221
  v_mfma_f32_16x16x32_bf16 v[40:43], v[80:83], v[184:187], v[40:43]
  v_cvt_pk_bf16_f32 v55, v222, v223
  s_waitcnt vmcnt(9)
  v_mfma_f32_16x16x32_bf16 v[28:31], v[84:87], v[140:143], v[28:31]
  v_cvt_pk_bf16_f32 v58, v224, v225
  v_mfma_f32_16x16x32_bf16 v[32:35], v[84:87], v[156:159], v[32:35]
  v_cvt_pk_bf16_f32 v59, v226, v227
  v_mfma_f32_16x16x32_bf16 v[36:39], v[84:87], v[172:175], v[36:39]
  v_mfma_f32_16x16x32_bf16 v[40:43], v[84:87], v[188:191], v[40:43]
  s_waitcnt vmcnt(8)
  v_mfma_f32_16x16x32_bf16 v[28:31], v[88:91], v[144:147], v[28:31]
  v_mfma_f32_16x16x32_bf16 v[32:35], v[88:91], v[160:163], v[32:35]
  v_mfma_f32_16x16x32_bf16 v[36:39], v[88:91], v[176:179], v[36:39]
  v_mfma_f32_16x16x32_bf16 v[40:43], v[88:91], v[192:195], v[40:43]
  s_waitcnt vmcnt(7)
  v_mfma_f32_16x16x32_bf16 v[196:199], v[92:95], v[132:135], 0
  v_permlane16_swap_b32 v44, v46
  v_permlane16_swap_b32 v45, v47
  v_mfma_f32_16x16x32_bf16 v[200:203], v[92:95], v[148:151], 0
  buffer_store_dwordx4 v[44:47], v16, s[40:43], s52 offen offset:0
  v_permlane16_swap_b32 v48, v50
  v_mfma_f32_16x16x32_bf16 v[204:207], v[92:95], v[164:167], 0
  v_permlane16_swap_b32 v49, v51
  buffer_store_dwordx4 v[48:51], v18, s[40:43], s52 offen offset:0
  v_mfma_f32_16x16x32_bf16 v[208:211], v[92:95], v[180:183], 0
  v_cvt_pk_bf16_f32 v76, v28, v29
  v_cvt_pk_bf16_f32 v77, v30, v31
  s_waitcnt vmcnt(8)
  v_mfma_f32_16x16x32_bf16 v[196:199], v[96:99], v[136:139], v[196:199]
  v_cvt_pk_bf16_f32 v80, v32, v33
  v_cvt_pk_bf16_f32 v81, v34, v35
  v_mfma_f32_16x16x32_bf16 v[200:203], v[96:99], v[152:155], v[200:203]
  v_cvt_pk_bf16_f32 v84, v36, v37
  v_cvt_pk_bf16_f32 v85, v38, v39
  v_mfma_f32_16x16x32_bf16 v[204:207], v[96:99], v[168:171], v[204:207]
  v_cvt_pk_bf16_f32 v88, v40, v41
  v_cvt_pk_bf16_f32 v89, v42, v43
  v_mfma_f32_16x16x32_bf16 v[208:211], v[96:99], v[184:187], v[208:211]
  v_permlane16_swap_b32 v52, v54
  v_permlane16_swap_b32 v53, v55
  s_waitcnt vmcnt(7)
  v_mfma_f32_16x16x32_bf16 v[196:199], v[100:103], v[140:143], v[196:199]
  buffer_store_dwordx4 v[52:55], v19, s[40:43], s52 offen offset:0
  v_permlane16_swap_b32 v56, v58
  v_mfma_f32_16x16x32_bf16 v[200:203], v[100:103], v[156:159], v[200:203]
  v_permlane16_swap_b32 v57, v59
  buffer_store_dwordx4 v[56:59], v20, s[40:43], s52 offen offset:0
  v_mfma_f32_16x16x32_bf16 v[204:207], v[100:103], v[172:175], v[204:207]
  v_mfma_f32_16x16x32_bf16 v[208:211], v[100:103], v[188:191], v[208:211]
  s_waitcnt vmcnt(8)
  v_mfma_f32_16x16x32_bf16 v[196:199], v[104:107], v[144:147], v[196:199]
  v_mfma_f32_16x16x32_bf16 v[200:203], v[104:107], v[160:163], v[200:203]
  v_mfma_f32_16x16x32_bf16 v[204:207], v[104:107], v[176:179], v[204:207]
  v_mfma_f32_16x16x32_bf16 v[208:211], v[104:107], v[192:195], v[208:211]
  s_waitcnt vmcnt(7)
  v_mfma_f32_16x16x32_bf16 v[212:215], v[108:111], v[132:135], 0
  s_nop 0
  v_mfma_f32_16x16x32_bf16 v[216:219], v[108:111], v[148:151], 0
  s_nop 0
  v_mfma_f32_16x16x32_bf16 v[220:223], v[108:111], v[164:167], 0
  v_cvt_pk_bf16_f32 v78, v196, v197
  v_mfma_f32_16x16x32_bf16 v[224:227], v[108:111], v[180:183], 0
  v_cvt_pk_bf16_f32 v79, v198, v199
  s_waitcnt vmcnt(6)
  v_mfma_f32_16x16x32_bf16 v[212:215], v[112:115], v[136:139], v[212:215]
  v_cvt_pk_bf16_f32 v82, v200, v201
  v_mfma_f32_16x16x32_bf16 v[216:219], v[112:115], v[152:155], v[216:219]
  v_cvt_pk_bf16_f32 v83, v202, v203
  v_mfma_f32_16x16x32_bf16 v[220:223], v[112:115], v[168:171], v[220:223]
  v_cvt_pk_bf16_f32 v86, v204, v205
  v_mfma_f32_16x16x32_bf16 v[224:227], v[112:115], v[184:187], v[224:227]
  v_cvt_pk_bf16_f32 v87, v206, v207
  s_waitcnt vmcnt(5)
  v_mfma_f32_16x16x32_bf16 v[212:215], v[116:119], v[140:143], v[212:215]
  v_cvt_pk_bf16_f32 v90, v208, v209
  v_mfma_f32_16x16x32_bf16 v[216:219], v[116:119], v[156:159], v[216:219]
  v_cvt_pk_bf16_f32 v91, v210, v211
  v_mfma_f32_16x16x32_bf16 v[220:223], v[116:119], v[172:175], v[220:223]
  v_mfma_f32_16x16x32_bf16 v[224:227], v[116:119], v[188:191], v[224:227]
  s_waitcnt vmcnt(4)
  v_mfma_f32_16x16x32_bf16 v[212:215], v[120:123], v[144:147], v[212:215]
  v_mfma_f32_16x16x32_bf16 v[216:219], v[120:123], v[160:163], v[216:219]
  v_mfma_f32_16x16x32_bf16 v[220:223], v[120:123], v[176:179], v[220:223]
  v_mfma_f32_16x16x32_bf16 v[224:227], v[120:123], v[192:195], v[224:227]
  v_permlane16_swap_b32 v76, v78
  v_permlane16_swap_b32 v77, v79
  buffer_store_dwordx4 v[76:79], v16, s[40:43], s52 offen offset:64
  v_permlane16_swap_b32 v80, v82
  v_permlane16_swap_b32 v81, v83
  buffer_store_dwordx4 v[80:83], v18, s[40:43], s52 offen offset:64
  v_permlane16_swap_b32 v84, v86
  v_permlane16_swap_b32 v85, v87
  buffer_store_dwordx4 v[84:87], v19, s[40:43], s52 offen offset:64
  v_permlane16_swap_b32 v88, v90
  v_permlane16_swap_b32 v89, v91
  buffer_store_dwordx4 v[88:91], v20, s[40:43], s52 offen offset:64
  v_cvt_pk_bf16_f32 v108, v212, v213
  v_cvt_pk_bf16_f32 v109, v214, v215
  v_cvt_pk_bf16_f32 v112, v216, v217
  v_cvt_pk_bf16_f32 v113, v218, v219
  v_cvt_pk_bf16_f32 v116, v220, v221
  v_cvt_pk_bf16_f32 v117, v222, v223
  v_cvt_pk_bf16_f32 v120, v224, v225
  v_cvt_pk_bf16_f32 v121, v226, v227
  buffer_store_dwordx2 v[108:109], v21, s[40:43], s52 offen offset:128
  buffer_store_dwordx2 v[112:113], v22, s[40:43], s52 offen offset:128
  buffer_store_dwordx2 v[116:117], v23, s[40:43], s52 offen offset:128
  buffer_store_dwordx2 v[120:121], v24, s[40:43], s52 offen offset:128
L_fin:
L_end:
  s_endpgm
.section .rodata,"a"
.p2align 6
.amdhsa_kernel concat_heads__linear_kernel_hedgehog__spectral_fnet__prompt_kernel
  .amdhsa_next_free_vgpr 256
  .amdhsa_next_free_sgpr 102
  .amdhsa_accum_offset 256
  .amdhsa_group_segment_fixed_size 0
  .amdhsa_kernarg_size 96
  .amdhsa_user_sgpr_count 2
  .amdhsa_user_sgpr_kernarg_segment_ptr 1
  .amdhsa_system_sgpr_workgroup_id_x 1
.end_amdhsa_kernel
```
